```python
import torch

def _softmax(x, axis=-1):
    return torch.softmax(x, dim=axis)
def _gelu(x):
    return torch.nn.functional.gelu(x, approximate="tanh")
def _silu(x):
    return torch.nn.functional.silu(x)
def _sigmoid(x):
    return torch.sigmoid(x)
def _layernorm(x, axis=-1, eps=1e-5):
    m = x.mean(dim=axis, keepdim=True)
    v = x.var(dim=axis, keepdim=True, unbiased=False)
    return (x - m) / torch.sqrt(v + eps)
def _scatter_add(tgt, idx, src, axis=0):
    return tgt.clone().index_add_(axis, idx, src)
def _segment_sum(src, seg, n):
    out = torch.zeros((n,) + src.shape[1:], dtype=src.dtype)
    return out.index_add_(0, seg, src)
def _pad(x, pw):
    flat = tuple(v for pair in reversed(pw) for v in pair)
    return torch.nn.functional.pad(x, flat)

kernel_name = 'gather_scatter__mpnn_edge_mlp__graph'

def setup_inputs():

    _w = (lambda a: (lambda t: t.to(torch.bfloat16) if t.is_floating_point() else t)(torch.as_tensor(a)))
    N, deg, D, De = 12500, 32, 128, max(16, 1)
    E = N * deg
    return {
        "x": _w((lambda *s: torch.randn(*s, dtype=torch.bfloat16) * 0.05)(N, D)),
        "e_attr": _w((lambda *s: torch.randn(*s, dtype=torch.bfloat16) * 0.4)(E, De)),
        "src": _w((lambda lo, hi, *s: torch.randint(lo, hi, s))(0, N, E).to(torch.int64)),
        "dst": _w((lambda lo, hi, *s: torch.randint(lo, hi, s))(0, N, E).to(torch.int64)),
        "w_msg": _w((lambda *s: torch.randn(*s, dtype=torch.bfloat16) * 0.4)(2 * D + De, D)),
        "w_upd": _w((lambda *s: torch.randn(*s, dtype=torch.bfloat16) * 0.05)(2 * D, D)),
    }

def reference(x, e_attr, src, dst, w_msg, w_upd):
    N, D = x.shape
    m_in = torch.concatenate([x[src], x[dst], e_attr], axis=-1)
    msg = _silu(m_in @ w_msg)
    agg = _segment_sum(msg, dst, N)
    return _silu(torch.concatenate([x, agg], axis=-1) @ w_upd)
```

```asm
; @launch kernel=pre_kernel grid=(254,1,1) block=(512,1,1) lds=98304
; @launch kernel=main_kernel grid=(256,1,1) block=(512,1,1) lds=162560
.amdgcn_target "amdgcn-amd-amdhsa--gfx950"
.text
.globl pre_kernel
.p2align 8
.type pre_kernel,@function
pre_kernel:
    s_cmp_ge_u32 s2, 254
    s_cbranch_scc1 L_pre_end
    s_load_dwordx2 s[28:29], s[0:1], 24
    s_load_dwordx2 s[20:21], s[0:1], 0
    s_load_dwordx2 s[24:25], s[0:1], 16
    s_load_dwordx4 s[12:15], s[0:1], 32
    s_load_dwordx2 s[36:37], s[0:1], 64
    v_lshrrev_b32 v2, 6, v0
    v_and_b32 v3, 63, v0
    v_readfirstlane_b32 s3, v2
    s_mov_b32 s38, 0x1000000
    s_mov_b32 s39, 0x20000
    s_cmp_ge_u32 s2, 125
    s_cbranch_scc0 L_p_head
L_pre_gemm:
    s_sub_u32 s40, s2, 125
    s_sub_u32 s41, s40, 125
    s_mov_b32 s42, 0
    s_cmp_eq_u32 s41, 0
    s_cselect_b32 s42, 0x8000, s42
    s_cmp_eq_u32 s41, 2
    s_cselect_b32 s42, 0x8000, s42
    s_cmp_eq_u32 s41, 3
    s_cselect_b32 s42, 0x10000, s42
    v_lshrrev_b32 v4, 4, v3
    v_and_b32 v5, 15, v3
    v_lshlrev_b32 v6, 2, v4
    v_xor_b32 v6, v6, v5
    v_lshlrev_b32 v6, 4, v6
    v_lshl_add_u32 v6, v4, 8, v6
    s_lshl_b32 s43, s3, 12
    s_add_u32 s42, s42, s43
    v_xor_b32 v8, v4, v5
    v_lshlrev_b32 v8, 4, v8
    v_lshl_add_u32 v28, v4, 8, v8
    v_xor_b32 v29, 64, v28
    v_xor_b32 v30, 128, v28
    v_xor_b32 v31, 192, v28
    s_add_u32 s44, s43, 32768
    s_mov_b32 m0, s44
    s_mul_i32 s45, s40, 25600
    s_add_u32 s50, s45, 25600
    s_min_u32 s22, s50, 0x30d400
    s_mov_b32 s23, 0x20000
    s_mov_b32 s35, 0x20000
    s_add_u32 s44, s45, s43
    s_lshr_b32 s51, s2, 3
    s_and_b32 s51, s51, 7
    s_lshl_b32 s51, s51, 12
    v_lshlrev_b32 v9, 7, v3
    s_add_u32 s54, s50, 4096
    s_mov_b32 s55, 0x20000
    s_sub_u32 s48, s41, 1
    s_cmp_lt_u32 s48, 2
    s_mov_b32 s48, 0x11000
    s_cselect_b32 s34, 0x10000, s48
    s_waitcnt lgkmcnt(0)
    buffer_load_dwordx4 v28, s[20:23], s44 offen offset:0 lds
    buffer_load_dwordx4 v29, s[20:23], s44 offen offset:1024 lds
    buffer_load_dwordx4 v30, s[20:23], s44 offen offset:2048 lds
    buffer_load_dwordx4 v31, s[20:23], s44 offen offset:3072 lds
    s_cselect_b32 s32, s14, s12
    s_cselect_b32 s33, s15, s13
    s_mov_b32 s52, s36
    s_mov_b32 s53, s37
    s_cmp_lg_u32 s3, 7
    s_cbranch_scc1 L_g_not
    s_mov_b64 exec, 0xffffffff
    buffer_load_dword v159, v9, s[32:35], s51 offen
    s_mov_b64 exec, -1
    s_waitcnt vmcnt(0)
L_g_not:
    s_branch L_g_rest
L_p_head:
    s_mul_i32 s40, s2, 12800
    s_add_u32 s41, s40, 8192
    v_lshlrev_b32 v1, 4, v0
    s_mov_b32 s26, 0x186a00
    s_mov_b32 s27, 0x20000
    s_mov_b32 s30, 0x186a00
    s_mov_b32 s31, 0x20000
    v_mul_u32_u24 v4, 12, v0
    s_getpc_b64 s[70:71]
L_pcp:
    v_lshlrev_b32 v101, 5, v0
    v_add_u32 v101, main_kernel-L_pcp, v101
    v_min_u32 v101, L_main_end-L_pcp, v101
    v_mov_b32 v103, s71
    v_add_co_u32 v102, vcc, s70, v101
    v_addc_co_u32 v103, vcc, 0, v103, vcc
    s_cmp_ge_u32 s3, 6
    s_waitcnt lgkmcnt(0)
    buffer_load_dwordx4 v[8:11], v1, s[28:31], s40 offen
    s_cbranch_scc1 L_p_no2
    buffer_load_dwordx3 v[12:14], v4, s[28:31], s41 offen
    buffer_load_dwordx3 v[20:22], v4, s[24:27], s41 offen
L_p_no2:
    buffer_load_dwordx4 v[16:19], v1, s[24:27], s40 offen
    global_load_dword v100, v[102:103], off
    v_min_u32 v40, 256, v0
    v_cmp_gt_u32 vcc, 256, v0
    v_mul_u32_u24 v40, 132, v40
    v_mov_b32 v42, 4
    v_mov_b32 v41, 0
    v_cndmask_b32 v43, v41, v42, vcc
    ds_write_b32 v40, v43
    v_mov_b32 v36, 0
    v_mov_b32 v37, 0
    v_mov_b32 v38, 0
    v_lshlrev_b32 v48, 16, v0
    v_add_u32 v48, 0x4000000, v48
    v_add_u32 v49, 0x4000, v48
    v_add_u32 v50, 0x8000, v48
    v_add_u32 v51, 0xc000, v48
    v_mul_u32_u24 v52, 0xc000, v0
    v_add_u32 v52, 0x6000000, v52
    v_add_u32 v53, 0x4000, v52
    v_add_u32 v54, 0x8000, v52
    s_mov_b32 s46, 132
    v_lshrrev_b32 v44, 3, v0
    v_and_b32 v46, 7, v0
    v_mul_u32_u24 v45, 132, v44
    v_lshlrev_b32 v47, 14, v44
    v_lshl_add_u32 v47, v46, 4, v47
    v_and_b32 v60, 4, v0
    v_lshlrev_b32 v60, 4, v60
    v_and_b32 v46, 3, v0
    v_lshl_add_u32 v56, v46, 2, v45
    v_add_u32 v56, v56, v60
    v_add_u32 v57, 8448, v56
    v_add_u32 v58, 16896, v56
    v_add_u32 v59, 25344, v56
    s_lshl_b32 s47, s2, 7
    s_add_u32 s47, s47, 0x400000
    s_waitcnt lgkmcnt(0)
    s_barrier
    s_cmp_ge_u32 s3, 6
    s_cbranch_scc1 L_p_short
    s_waitcnt vmcnt(4)
    v_mul_u32_u24_sdwa v24, s46, v8 dst_sel:DWORD dst_unused:UNUSED_PAD src0_sel:DWORD src1_sel:BYTE_0
    v_lshlrev_b32_sdwa v8, 26, v8 dst_sel:DWORD dst_unused:UNUSED_PAD src0_sel:DWORD src1_sel:BYTE_1
    ds_add_rtn_u32 v32, v24, v42
    v_mul_u32_u24_sdwa v25, s46, v9 dst_sel:DWORD dst_unused:UNUSED_PAD src0_sel:DWORD src1_sel:BYTE_0
    v_lshlrev_b32_sdwa v9, 26, v9 dst_sel:DWORD dst_unused:UNUSED_PAD src0_sel:DWORD src1_sel:BYTE_1
    ds_add_rtn_u32 v33, v25, v42
    v_mul_u32_u24_sdwa v26, s46, v10 dst_sel:DWORD dst_unused:UNUSED_PAD src0_sel:DWORD src1_sel:BYTE_0
    v_lshlrev_b32_sdwa v10, 26, v10 dst_sel:DWORD dst_unused:UNUSED_PAD src0_sel:DWORD src1_sel:BYTE_1
    ds_add_rtn_u32 v34, v26, v42
    v_mul_u32_u24_sdwa v27, s46, v11 dst_sel:DWORD dst_unused:UNUSED_PAD src0_sel:DWORD src1_sel:BYTE_0
    v_lshlrev_b32_sdwa v11, 26, v11 dst_sel:DWORD dst_unused:UNUSED_PAD src0_sel:DWORD src1_sel:BYTE_1
    ds_add_rtn_u32 v35, v27, v42
    s_waitcnt vmcnt(3)
    v_mul_u32_u24_sdwa v28, s46, v12 dst_sel:DWORD dst_unused:UNUSED_PAD src0_sel:DWORD src1_sel:BYTE_0
    v_lshlrev_b32_sdwa v12, 26, v12 dst_sel:DWORD dst_unused:UNUSED_PAD src0_sel:DWORD src1_sel:BYTE_1
    ds_add_rtn_u32 v36, v28, v42
    v_mul_u32_u24_sdwa v29, s46, v13 dst_sel:DWORD dst_unused:UNUSED_PAD src0_sel:DWORD src1_sel:BYTE_0
    v_lshlrev_b32_sdwa v13, 26, v13 dst_sel:DWORD dst_unused:UNUSED_PAD src0_sel:DWORD src1_sel:BYTE_1
    ds_add_rtn_u32 v37, v29, v42
    v_mul_u32_u24_sdwa v30, s46, v14 dst_sel:DWORD dst_unused:UNUSED_PAD src0_sel:DWORD src1_sel:BYTE_0
    v_lshlrev_b32_sdwa v14, 26, v14 dst_sel:DWORD dst_unused:UNUSED_PAD src0_sel:DWORD src1_sel:BYTE_1
    ds_add_rtn_u32 v38, v30, v42
    s_waitcnt vmcnt(2)
    v_add3_u32 v20, v20, v12, v52
    v_add3_u32 v21, v21, v13, v53
    v_add3_u32 v22, v22, v14, v54
    s_waitcnt lgkmcnt(0)
    v_min_u32 v44, 128, v36
    v_add_u32 v44, v44, v28
    ds_write_b32 v44, v20
    v_min_u32 v44, 128, v37
    v_add_u32 v44, v44, v29
    ds_write_b32 v44, v21
    v_min_u32 v44, 128, v38
    v_add_u32 v44, v44, v30
    ds_write_b32 v44, v22
    s_branch L_p_join
L_p_short:
    s_waitcnt vmcnt(2)
    v_mul_u32_u24_sdwa v24, s46, v8 dst_sel:DWORD dst_unused:UNUSED_PAD src0_sel:DWORD src1_sel:BYTE_0
    v_lshlrev_b32_sdwa v8, 26, v8 dst_sel:DWORD dst_unused:UNUSED_PAD src0_sel:DWORD src1_sel:BYTE_1
    ds_add_rtn_u32 v32, v24, v42
    v_mul_u32_u24_sdwa v25, s46, v9 dst_sel:DWORD dst_unused:UNUSED_PAD src0_sel:DWORD src1_sel:BYTE_0
    v_lshlrev_b32_sdwa v9, 26, v9 dst_sel:DWORD dst_unused:UNUSED_PAD src0_sel:DWORD src1_sel:BYTE_1
    ds_add_rtn_u32 v33, v25, v42
    v_mul_u32_u24_sdwa v26, s46, v10 dst_sel:DWORD dst_unused:UNUSED_PAD src0_sel:DWORD src1_sel:BYTE_0
    v_lshlrev_b32_sdwa v10, 26, v10 dst_sel:DWORD dst_unused:UNUSED_PAD src0_sel:DWORD src1_sel:BYTE_1
    ds_add_rtn_u32 v34, v26, v42
    v_mul_u32_u24_sdwa v27, s46, v11 dst_sel:DWORD dst_unused:UNUSED_PAD src0_sel:DWORD src1_sel:BYTE_0
    v_lshlrev_b32_sdwa v11, 26, v11 dst_sel:DWORD dst_unused:UNUSED_PAD src0_sel:DWORD src1_sel:BYTE_1
    ds_add_rtn_u32 v35, v27, v42
    s_waitcnt lgkmcnt(0)
L_p_join:
    s_waitcnt vmcnt(1)
    v_add3_u32 v16, v16, v8, v48
    v_add3_u32 v17, v17, v9, v49
    v_add3_u32 v18, v18, v10, v50
    v_add3_u32 v19, v19, v11, v51
    v_min_u32 v44, 128, v32
    v_add_u32 v44, v44, v24
    ds_write_b32 v44, v16
    v_min_u32 v44, 128, v33
    v_add_u32 v44, v44, v25
    ds_write_b32 v44, v17
    v_min_u32 v44, 128, v34
    v_add_u32 v44, v44, v26
    ds_write_b32 v44, v18
    v_min_u32 v44, 128, v35
    v_add_u32 v44, v44, v27
    ds_write_b32 v44, v19
    v_max3_u32 v44, v32, v33, v34
    v_max3_u32 v44, v44, v35, v36
    v_max3_u32 v44, v44, v37, v38
    v_cmp_lt_u32 vcc, 124, v44
    s_cbranch_vccz L_p_noovf
    s_add_u32 s44, s40, 0x910000
    s_add_u32 s45, s40, 0xb00000
    v_cmp_lt_u32 vcc, 124, v32
    s_mov_b64 exec, vcc
    s_cbranch_execz L_p_ov0
    ds_add_rtn_u32 v44, v41, v42 offset:33792
    s_waitcnt lgkmcnt(0)
    buffer_store_dword v16, v44, s[36:39], s44 offen
    buffer_store_dword v24, v44, s[36:39], s45 offen
    s_waitcnt vmcnt(0)
L_p_ov0:
    s_mov_b64 exec, -1
    v_cmp_lt_u32 vcc, 124, v33
    s_mov_b64 exec, vcc
    s_cbranch_execz L_p_ov1
    ds_add_rtn_u32 v44, v41, v42 offset:33792
    s_waitcnt lgkmcnt(0)
    buffer_store_dword v17, v44, s[36:39], s44 offen
    buffer_store_dword v25, v44, s[36:39], s45 offen
    s_waitcnt vmcnt(0)
L_p_ov1:
    s_mov_b64 exec, -1
    v_cmp_lt_u32 vcc, 124, v34
    s_mov_b64 exec, vcc
    s_cbranch_execz L_p_ov2
    ds_add_rtn_u32 v44, v41, v42 offset:33792
    s_waitcnt lgkmcnt(0)
    buffer_store_dword v18, v44, s[36:39], s44 offen
    buffer_store_dword v26, v44, s[36:39], s45 offen
    s_waitcnt vmcnt(0)
L_p_ov2:
    s_mov_b64 exec, -1
    v_cmp_lt_u32 vcc, 124, v35
    s_mov_b64 exec, vcc
    s_cbranch_execz L_p_ov3
    ds_add_rtn_u32 v44, v41, v42 offset:33792
    s_waitcnt lgkmcnt(0)
    buffer_store_dword v19, v44, s[36:39], s44 offen
    buffer_store_dword v27, v44, s[36:39], s45 offen
    s_waitcnt vmcnt(0)
L_p_ov3:
    s_mov_b64 exec, -1
    v_cmp_lt_u32 vcc, 124, v36
    s_mov_b64 exec, vcc
    s_cbranch_execz L_p_ov4
    ds_add_rtn_u32 v44, v41, v42 offset:33792
    s_waitcnt lgkmcnt(0)
    buffer_store_dword v20, v44, s[36:39], s44 offen
    buffer_store_dword v28, v44, s[36:39], s45 offen
    s_waitcnt vmcnt(0)
L_p_ov4:
    s_mov_b64 exec, -1
    v_cmp_lt_u32 vcc, 124, v37
    s_mov_b64 exec, vcc
    s_cbranch_execz L_p_ov5
    ds_add_rtn_u32 v44, v41, v42 offset:33792
    s_waitcnt lgkmcnt(0)
    buffer_store_dword v21, v44, s[36:39], s44 offen
    buffer_store_dword v29, v44, s[36:39], s45 offen
    s_waitcnt vmcnt(0)
L_p_ov5:
    s_mov_b64 exec, -1
    v_cmp_lt_u32 vcc, 124, v38
    s_mov_b64 exec, vcc
    s_cbranch_execz L_p_ov6
    ds_add_rtn_u32 v44, v41, v42 offset:33792
    s_waitcnt lgkmcnt(0)
    buffer_store_dword v22, v44, s[36:39], s44 offen
    buffer_store_dword v30, v44, s[36:39], s45 offen
    s_waitcnt vmcnt(0)
L_p_ov6:
    s_mov_b64 exec, -1
L_p_noovf:
    s_waitcnt lgkmcnt(0)
    s_barrier
    ds_read_b32 v24, v45 offset:0
    ds_read2_b32 v[8:9], v56 offset0:0 offset1:4
    ds_read2_b32 v[10:11], v56 offset0:8 offset1:12
    ds_read_b32 v25, v45 offset:8448
    ds_read2_b32 v[12:13], v57 offset0:0 offset1:4
    ds_read2_b32 v[14:15], v57 offset0:8 offset1:12
    ds_read_b32 v26, v45 offset:16896
    ds_read2_b32 v[16:17], v58 offset0:0 offset1:4
    ds_read2_b32 v[18:19], v58 offset0:8 offset1:12
    ds_read_b32 v27, v45 offset:25344
    ds_read2_b32 v[20:21], v59 offset0:0 offset1:4
    ds_read2_b32 v[22:23], v59 offset0:8 offset1:12
    ds_read_b32 v28, v41 offset:33792
    s_waitcnt lgkmcnt(10)
    v_cmp_lt_u32 vcc, v60, v24
    s_mov_b64 exec, vcc
    buffer_store_dwordx4 v[8:11], v47, s[36:39], s47 offen sc1
    s_mov_b64 exec, -1
    s_add_u32 s47, s47, 0x100000
    s_waitcnt lgkmcnt(7)
    v_cmp_lt_u32 vcc, v60, v25
    s_mov_b64 exec, vcc
    buffer_store_dwordx4 v[12:15], v47, s[36:39], s47 offen sc1
    s_mov_b64 exec, -1
    s_add_u32 s47, s47, 0x100000
    s_waitcnt lgkmcnt(4)
    v_cmp_lt_u32 vcc, v60, v26
    s_mov_b64 exec, vcc
    buffer_store_dwordx4 v[16:19], v47, s[36:39], s47 offen sc1
    s_mov_b64 exec, -1
    s_add_u32 s47, s47, 0x100000
    s_waitcnt lgkmcnt(1)
    v_cmp_lt_u32 vcc, v60, v27
    s_mov_b64 exec, vcc
    buffer_store_dwordx4 v[20:23], v47, s[36:39], s47 offen sc1
    s_mov_b64 exec, -1
    s_cmp_lg_u32 s3, 0
    s_cbranch_scc1 L_pre_end
    s_lshl_b32 s44, s2, 2
    s_add_u32 s44, s44, 0x900000
    s_mov_b64 exec, 1
    s_waitcnt lgkmcnt(0)
    buffer_store_dword v28, v41, s[36:39], s44 offen
    s_endpgm
L_g_rest:
    s_and_b32 s46, s3, 3
    s_lshr_b32 s47, s3, 2
    s_lshl_b32 s49, s47, 1
    s_cmp_lt_u32 s40, 125
    s_cselect_b32 s49, s49, s46
    v_lshrrev_b32 v10, 5, v3
    v_and_b32 v11, 1, v4
    v_bfe_u32 v12, v3, 2, 2
    v_and_b32 v13, 1, v3
    v_bfe_u32 v14, v3, 1, 1
    v_lshl_add_u32 v15, v13, 1, v11
    v_lshl_add_u32 v16, v11, 1, v14
    s_cmp_eq_u32 s41, 3
    s_cselect_b64 vcc, -1, 0
    v_cndmask_b32 v15, v15, v16, vcc
    v_cndmask_b32 v16, v14, v13, vcc
    v_xor_b32 v17, s49, v12
    v_lshl_add_u32 v15, v17, 2, v15
    v_lshlrev_b32 v15, 4, v15
    v_lshl_add_u32 v15, v16, 3, v15
    v_lshl_add_u32 v17, v10, 3, v12
    v_lshl_add_u32 v15, v17, 8, v15
    v_and_b32 v18, 31, v3
    s_cmp_lt_u32 s40, 125
    s_cbranch_scc1 L_g_go
    s_mov_b32 m0, s43
    s_nop 0
    buffer_load_dwordx4 v6, s[32:35], s42 offen offset:0 lds
    buffer_load_dwordx4 v6, s[32:35], s42 offen offset:1024 lds
    buffer_load_dwordx4 v6, s[32:35], s42 offen offset:2048 lds
    buffer_load_dwordx4 v6, s[32:35], s42 offen offset:3072 lds
    s_waitcnt vmcnt(0)
    s_barrier
    s_branch L_g_frag
L_g_go:
    v_xor_b32 v16, 64, v15
    s_lshl_b32 s48, s46, 5
    v_add_u32 v19, s48, v18
    v_and_b32 v20, 15, v18
    v_xor_b32 v20, v20, v10
    v_lshlrev_b32 v20, 4, v20
    v_lshl_add_u32 v20, v19, 8, v20
    v_and_b32 v21, 7, v18
    v_lshlrev_b32 v22, 1, v10
    v_xor_b32 v21, v21, v22
    v_lshlrev_b32 v21, 4, v21
    v_lshl_add_u32 v21, v18, 7, v21
    s_add_u32 s48, s43, 65536
    v_add_u32 v21, s48, v21
    v_lshrrev_b32 v24, 3, v3
    v_and_b32 v25, 7, v3
    v_xor_b32 v22, v24, v25
    v_lshlrev_b32 v22, 4, v22
    v_lshl_add_u32 v22, v24, 7, v22
    v_add_u32 v22, s48, v22
    v_lshlrev_b32 v23, 4, v25
    v_lshl_add_u32 v23, v24, 8, v23
    s_lshl_b32 s48, s46, 13
    s_add_u32 s48, s48, s45
    s_lshl_b32 s49, s47, 7
    s_add_u32 s48, s48, s49
    s_add_u32 s48, s48, 4096
    s_add_u32 s49, s48, 4096
    v_xor_b32 v27, 16, v21
    v_xor_b32 v25, 64, v21
    v_xor_b32 v26, 80, v21
    s_waitcnt vmcnt(3)
    s_mov_b32 m0, s43
    s_nop 0
    buffer_load_dwordx4 v6, s[32:35], s42 offen offset:0 lds
    buffer_load_dwordx4 v6, s[32:35], s42 offen offset:1024 lds
    buffer_load_dwordx4 v6, s[32:35], s42 offen offset:2048 lds
    buffer_load_dwordx4 v6, s[32:35], s42 offen offset:3072 lds
    s_waitcnt vmcnt(4)
    s_barrier
    ds_read_b128 v[96:99], v20 offset:32768
    v_xor_b32 v24, 32, v20
    ds_read_b128 v[100:103], v24 offset:32768
    v_xor_b32 v24, 64, v20
    ds_read_b128 v[104:107], v24 offset:32768
    v_xor_b32 v24, 96, v20
    ds_read_b128 v[108:111], v24 offset:32768
    v_xor_b32 v24, 128, v20
    ds_read_b128 v[112:115], v24 offset:32768
    v_xor_b32 v24, 160, v20
    ds_read_b128 v[116:119], v24 offset:32768
    v_xor_b32 v24, 192, v20
    ds_read_b128 v[120:123], v24 offset:32768
    v_xor_b32 v24, 224, v20
    ds_read_b128 v[124:127], v24 offset:32768
    s_waitcnt vmcnt(0) lgkmcnt(0)
    s_barrier
    ds_read_b64_tr_b16 v[32:33], v15 offset:0
    ds_read_b64_tr_b16 v[34:35], v15 offset:1024
    ds_read_b64_tr_b16 v[36:37], v15 offset:4096
    ds_read_b64_tr_b16 v[38:39], v15 offset:5120
    ds_read_b64_tr_b16 v[40:41], v15 offset:8192
    ds_read_b64_tr_b16 v[42:43], v15 offset:9216
    ds_read_b64_tr_b16 v[44:45], v15 offset:12288
    ds_read_b64_tr_b16 v[46:47], v15 offset:13312
    ds_read_b64_tr_b16 v[48:49], v15 offset:16384
    ds_read_b64_tr_b16 v[50:51], v15 offset:17408
    ds_read_b64_tr_b16 v[52:53], v15 offset:20480
    ds_read_b64_tr_b16 v[54:55], v15 offset:21504
    s_waitcnt lgkmcnt(10)
    v_mfma_f32_32x32x16_bf16 v[128:143], v[32:35], v[96:99], 0
    ds_read_b64_tr_b16 v[56:57], v15 offset:24576
    ds_read_b64_tr_b16 v[58:59], v15 offset:25600
    s_waitcnt lgkmcnt(10)
    v_mfma_f32_32x32x16_bf16 v[128:143], v[36:39], v[100:103], v[128:143]
    ds_read_b64_tr_b16 v[60:61], v15 offset:28672
    ds_read_b64_tr_b16 v[62:63], v15 offset:29696
    s_waitcnt lgkmcnt(10)
    v_mfma_f32_32x32x16_bf16 v[128:143], v[40:43], v[104:107], v[128:143]
    ds_read_b64_tr_b16 v[64:65], v16 offset:0
    ds_read_b64_tr_b16 v[66:67], v16 offset:1024
    s_waitcnt lgkmcnt(10)
    v_mfma_f32_32x32x16_bf16 v[128:143], v[44:47], v[108:111], v[128:143]
    ds_read_b64_tr_b16 v[68:69], v16 offset:4096
    ds_read_b64_tr_b16 v[70:71], v16 offset:5120
    s_waitcnt lgkmcnt(10)
    v_mfma_f32_32x32x16_bf16 v[128:143], v[48:51], v[112:115], v[128:143]
    ds_read_b64_tr_b16 v[72:73], v16 offset:8192
    ds_read_b64_tr_b16 v[74:75], v16 offset:9216
    s_waitcnt lgkmcnt(10)
    v_mfma_f32_32x32x16_bf16 v[128:143], v[52:55], v[116:119], v[128:143]
    ds_read_b64_tr_b16 v[76:77], v16 offset:12288
    ds_read_b64_tr_b16 v[78:79], v16 offset:13312
    s_waitcnt lgkmcnt(10)
    v_mfma_f32_32x32x16_bf16 v[128:143], v[56:59], v[120:123], v[128:143]
    ds_read_b64_tr_b16 v[80:81], v16 offset:16384
    ds_read_b64_tr_b16 v[82:83], v16 offset:17408
    s_waitcnt lgkmcnt(10)
    v_mfma_f32_32x32x16_bf16 v[128:143], v[60:63], v[124:127], v[128:143]
    ds_read_b64_tr_b16 v[84:85], v16 offset:20480
    ds_read_b64_tr_b16 v[86:87], v16 offset:21504
    s_waitcnt lgkmcnt(10)
    v_mfma_f32_32x32x16_bf16 v[144:159], v[64:67], v[96:99], 0
    ds_read_b64_tr_b16 v[88:89], v16 offset:24576
    ds_read_b64_tr_b16 v[90:91], v16 offset:25600
    s_waitcnt lgkmcnt(10)
    v_mfma_f32_32x32x16_bf16 v[144:159], v[68:71], v[100:103], v[144:159]
    ds_read_b64_tr_b16 v[92:93], v16 offset:28672
    ds_read_b64_tr_b16 v[94:95], v16 offset:29696
    s_waitcnt lgkmcnt(10)
    v_mfma_f32_32x32x16_bf16 v[144:159], v[72:75], v[104:107], v[144:159]
    s_nop 3
    v_mul_f32 v128, 0xbfb8aa3b, v128
    v_mul_f32 v129, 0xbfb8aa3b, v129
    v_mul_f32 v130, 0xbfb8aa3b, v130
    v_mul_f32 v131, 0xbfb8aa3b, v131
    s_waitcnt lgkmcnt(8)
    v_mfma_f32_32x32x16_bf16 v[144:159], v[76:79], v[108:111], v[144:159]
    v_mul_f32 v132, 0xbfb8aa3b, v132
    v_mul_f32 v133, 0xbfb8aa3b, v133
    v_mul_f32 v134, 0xbfb8aa3b, v134
    v_mul_f32 v135, 0xbfb8aa3b, v135
    s_waitcnt lgkmcnt(6)
    v_mfma_f32_32x32x16_bf16 v[144:159], v[80:83], v[112:115], v[144:159]
    v_mul_f32 v136, 0xbfb8aa3b, v136
    v_mul_f32 v137, 0xbfb8aa3b, v137
    v_mul_f32 v138, 0xbfb8aa3b, v138
    v_mul_f32 v139, 0xbfb8aa3b, v139
    s_waitcnt lgkmcnt(4)
    v_mfma_f32_32x32x16_bf16 v[144:159], v[84:87], v[116:119], v[144:159]
    v_mul_f32 v140, 0xbfb8aa3b, v140
    v_mul_f32 v141, 0xbfb8aa3b, v141
    v_mul_f32 v142, 0xbfb8aa3b, v142
    v_mul_f32 v143, 0xbfb8aa3b, v143
    s_waitcnt lgkmcnt(2)
    v_mfma_f32_32x32x16_bf16 v[144:159], v[88:91], v[120:123], v[144:159]
    v_cvt_pk_bf16_f32 v128, v128, v129
    v_cvt_pk_bf16_f32 v129, v130, v131
    v_cvt_pk_bf16_f32 v130, v132, v133
    v_cvt_pk_bf16_f32 v131, v134, v135
    s_waitcnt lgkmcnt(0)
    v_mfma_f32_32x32x16_bf16 v[144:159], v[92:95], v[124:127], v[144:159]
    v_cvt_pk_bf16_f32 v132, v136, v137
    v_cvt_pk_bf16_f32 v133, v138, v139
    v_cvt_pk_bf16_f32 v134, v140, v141
    v_cvt_pk_bf16_f32 v135, v142, v143
    ds_write_b128 v21, v[128:131]
    ds_write_b128 v27, v[132:135]
    s_nop 5
    v_mul_f32 v144, 0xbfb8aa3b, v144
    v_mul_f32 v145, 0xbfb8aa3b, v145
    v_mul_f32 v146, 0xbfb8aa3b, v146
    v_mul_f32 v147, 0xbfb8aa3b, v147
    v_mul_f32 v148, 0xbfb8aa3b, v148
    v_mul_f32 v149, 0xbfb8aa3b, v149
    v_mul_f32 v150, 0xbfb8aa3b, v150
    v_mul_f32 v151, 0xbfb8aa3b, v151
    v_mul_f32 v152, 0xbfb8aa3b, v152
    v_mul_f32 v153, 0xbfb8aa3b, v153
    v_mul_f32 v154, 0xbfb8aa3b, v154
    v_mul_f32 v155, 0xbfb8aa3b, v155
    v_mul_f32 v156, 0xbfb8aa3b, v156
    v_mul_f32 v157, 0xbfb8aa3b, v157
    v_mul_f32 v158, 0xbfb8aa3b, v158
    v_mul_f32 v159, 0xbfb8aa3b, v159
    v_cvt_pk_bf16_f32 v144, v144, v145
    v_cvt_pk_bf16_f32 v145, v146, v147
    v_cvt_pk_bf16_f32 v146, v148, v149
    v_cvt_pk_bf16_f32 v147, v150, v151
    v_cvt_pk_bf16_f32 v148, v152, v153
    v_cvt_pk_bf16_f32 v149, v154, v155
    v_cvt_pk_bf16_f32 v150, v156, v157
    v_cvt_pk_bf16_f32 v151, v158, v159
    ds_write_b128 v25, v[144:147]
    ds_write_b128 v26, v[148:151]
    ds_read_b128 v[96:99], v22 offset:0
    ds_read_b128 v[100:103], v22 offset:1024
    ds_read_b128 v[104:107], v22 offset:2048
    ds_read_b128 v[108:111], v22 offset:3072
    s_waitcnt lgkmcnt(3)
    buffer_store_dwordx4 v[96:99], v23, s[52:55], s48 offen offset:0 sc1
    s_waitcnt lgkmcnt(2)
    buffer_store_dwordx4 v[100:103], v23, s[52:55], s48 offen offset:2048 sc1
    s_waitcnt lgkmcnt(1)
    buffer_store_dwordx4 v[104:107], v23, s[52:55], s49 offen offset:0 sc1
    s_waitcnt lgkmcnt(0)
    buffer_store_dwordx4 v[108:111], v23, s[52:55], s49 offen offset:2048 sc1
    s_endpgm
L_g_frag:
    v_lshlrev_b32 v22, 4, v3
    s_cmp_eq_u32 s41, 3
    s_cbranch_scc1 L_g_w3
    s_lshl_b32 s48, s3, 1
    v_add_u32 v15, s48, v14
    s_cmp_eq_u32 s41, 2
    s_cbranch_scc1 L_g_wu2
    v_lshlrev_b32 v16, 2, v12
    v_xor_b32 v16, v16, v15
    v_lshlrev_b32 v16, 4, v16
    v_lshl_add_u32 v16, v13, 3, v16
    v_lshl_add_u32 v17, v4, 3, v12
    v_lshl_add_u32 v16, v17, 8, v16
    ds_read_b64_tr_b16 v[32:33], v16 offset:0
    ds_read_b64_tr_b16 v[34:35], v16 offset:1024
    ds_read_b64_tr_b16 v[36:37], v16 offset:8192
    ds_read_b64_tr_b16 v[38:39], v16 offset:9216
    ds_read_b64_tr_b16 v[40:41], v16 offset:16384
    ds_read_b64_tr_b16 v[42:43], v16 offset:17408
    ds_read_b64_tr_b16 v[44:45], v16 offset:24576
    ds_read_b64_tr_b16 v[46:47], v16 offset:25600
    s_branch L_g_fst
L_g_wu2:
    v_lshlrev_b32 v16, 2, v4
    v_xor_b32 v16, v16, v15
    v_lshlrev_b32 v16, 4, v16
    v_lshl_add_u32 v16, v13, 3, v16
    v_lshl_add_u32 v17, v12, 5, v4
    v_lshl_add_u32 v16, v17, 8, v16
    ds_read_b64_tr_b16 v[32:33], v16 offset:0
    ds_read_b64_tr_b16 v[36:37], v16 offset:1024
    ds_read_b64_tr_b16 v[40:41], v16 offset:2048
    ds_read_b64_tr_b16 v[44:45], v16 offset:3072
    ds_read_b64_tr_b16 v[34:35], v16 offset:4096
    ds_read_b64_tr_b16 v[38:39], v16 offset:5120
    ds_read_b64_tr_b16 v[42:43], v16 offset:6144
    ds_read_b64_tr_b16 v[46:47], v16 offset:7168
L_g_fst:
    s_lshl_b32 s48, s41, 15
    s_lshl_b32 s49, s3, 12
    s_add_u32 s48, s48, s49
    s_add_u32 s48, s48, 0x800000
    s_waitcnt lgkmcnt(0)
    buffer_store_dwordx4 v[32:35], v22, s[36:39], s48 offen offset:0
    buffer_store_dwordx4 v[36:39], v22, s[36:39], s48 offen offset:1024
    buffer_store_dwordx4 v[40:43], v22, s[36:39], s48 offen offset:2048
    buffer_store_dwordx4 v[44:47], v22, s[36:39], s48 offen offset:3072
    s_endpgm
L_g_w3:
    s_cmp_lg_u32 s47, 0
    s_cbranch_scc1 L_pre_end
    ds_read_b64_tr_b16 v[32:33], v15 offset:0
    ds_read_b64_tr_b16 v[34:35], v15 offset:1024
    s_lshl_b32 s48, s46, 10
    s_add_u32 s48, s48, 0x818000
    s_waitcnt lgkmcnt(0)
    v_lshlrev_b32 v40, 16, v32
    v_and_b32 v41, 0xffff0000, v32
    v_mul_f32 v40, 0xbfb8aa3b, v40
    v_mul_f32 v41, 0xbfb8aa3b, v41
    v_cvt_pk_bf16_f32 v32, v40, v41
    v_lshlrev_b32 v40, 16, v33
    v_and_b32 v41, 0xffff0000, v33
    v_mul_f32 v40, 0xbfb8aa3b, v40
    v_mul_f32 v41, 0xbfb8aa3b, v41
    v_cvt_pk_bf16_f32 v33, v40, v41
    v_lshlrev_b32 v40, 16, v34
    v_and_b32 v41, 0xffff0000, v34
    v_mul_f32 v40, 0xbfb8aa3b, v40
    v_mul_f32 v41, 0xbfb8aa3b, v41
    v_cvt_pk_bf16_f32 v34, v40, v41
    v_lshlrev_b32 v40, 16, v35
    v_and_b32 v41, 0xffff0000, v35
    v_mul_f32 v40, 0xbfb8aa3b, v40
    v_mul_f32 v41, 0xbfb8aa3b, v41
    v_cvt_pk_bf16_f32 v35, v40, v41
    buffer_store_dwordx4 v[32:35], v22, s[36:39], s48 offen
L_pre_end:
    s_endpgm
.globl main_kernel
.p2align 8
.type main_kernel,@function
main_kernel:
    s_cmp_ge_u32 s2, 256
    s_cbranch_scc1 L_main_end
    s_load_dwordx2 s[12:13], s[0:1], 64
    s_load_dwordx2 s[20:21], s[0:1], 0
    s_load_dwordx2 s[8:9], s[0:1], 64
    s_load_dwordx2 s[16:17], s[0:1], 8
    s_load_dwordx2 s[24:25], s[0:1], 48
    v_lshrrev_b32 v4, 6, v0
    v_and_b32 v1, 63, v0
    v_readfirstlane_b32 s28, v4
    v_and_b32 v2, 31, v0
    v_bfe_u32 v3, v0, 5, 1
    s_lshl_b32 s29, s2, 8
    s_mov_b32 s32, 0
    s_mov_b32 s34, 1
    s_mul_i32 s36, s28, 8192
    s_add_u32 s36, s36, 97024
    s_add_u32 s37, s36, 4096
    s_mov_b32 s92, 4096
    s_mov_b32 s93, 3072
    s_mov_b32 s94, 2048
    s_mov_b32 s95, 1024
    s_mov_b32 s96, 4224
    s_mov_b32 s97, 3200
    s_mov_b32 s98, 2176
    s_mov_b32 s99, 1152
    v_lshrrev_b32 v4, 4, v1
    v_and_b32 v5, 15, v1
    s_lshl_b32 s58, s28, 3
    v_add_u32 v6, s58, v4
    v_and_b32 v7, 15, v6
    v_xor_b32 v7, v7, v5
    v_lshlrev_b32 v7, 4, v7
    v_lshl_add_u32 v16, v6, 16, v7
    v_xor_b32 v17, 64, v16
    v_add_u32 v17, 261120, v17
    v_cmp_gt_u32 s[68:69], 49, v6
    s_lshl_b32 s58, s28, 11
    s_add_u32 s58, s58, 41792
    s_mov_b32 m0, s58
    s_mov_b32 s14, 0x1000000
    s_mov_b32 s15, 0x20000
    s_mov_b32 s22, 0x30d400
    s_mov_b32 s23, 0x20000
    s_mov_b32 s10, 0
    s_mov_b32 s11, 0x20000
    s_mov_b32 s18, 0
    s_mov_b32 s19, 0x20000
    s_mov_b32 s26, 0x30d400
    s_mov_b32 s27, 0x20000
    v_mov_b32 v212, 0
    v_and_b32 v9, 3, v0
    v_lshlrev_b32 v5, 5, v0
    v_lshlrev_b32 v9, 4, v9
    v_sub_u32 v5, v5, v9
    s_lshl_b32 s58, s2, 14
    s_add_u32 s58, s58, 0x400000
    v_cmp_gt_u32 vcc, 500, v0
    s_mov_b64 exec, vcc
    s_waitcnt lgkmcnt(0)
L_cells:
    buffer_load_dwordx4 v[212:215], v5, s[12:15], s58 offen
    buffer_load_dwordx4 v[216:219], v5, s[12:15], s58 offen offset:64
    s_mov_b64 exec, -1
    s_mov_b32 s35, 0
    s_cmp_eq_u32 s34, 0
    s_cbranch_scc1 L_skipfirst
    v_bfe_u32 v253, v2, 2, 1
    v_lshrrev_b32 v254, 1, v2
    v_and_b32 v254, 12, v254
    v_and_b32 v6, 3, v2
    v_lshlrev_b32 v240, 2, v6
    v_lshlrev_b32 v239, 4, v3
    v_lshlrev_b32 v243, 4, v1
    v_lshlrev_b32 v255, 7, v1
    s_cmp_lt_u32 s28, 6
    s_cbranch_scc0 L_x67
    buffer_load_dwordx4 v16, s[20:23], s29 offen lds
    buffer_load_dwordx4 v17, s[20:23], s29 offen offset:1024 lds
    s_branch L_xd
L_x67:
    s_lshr_b32 s58, s2, 3
    s_mul_i32 s58, s58, 3200
    s_add_u32 s58, s58, 0x800000
    v_lshlrev_b32 v9, 7, v1
    s_cmp_eq_u32 s28, 6
    s_cbranch_scc0 L_x7
    s_mov_b64 exec, s[68:69]
    buffer_load_dwordx4 v16, s[20:23], s29 offen lds
    s_mov_b64 exec, 0x1ffffff
    buffer_load_dword v251, v9, s[12:15], s58 offen
    s_branch L_x8
L_x7:
    s_mov_b32 s18, 0x0
    v_lshlrev_b32 v9, 18, v1
    buffer_load_dword v251, v9, s[16:19], 0 offen
    s_mov_b64 exec, 1
    buffer_load_dword v251, v9, s[12:15], 0 offen
L_x8:
    s_mov_b64 exec, -1
L_xd:
    s_lshl_b32 s58, s28, 9
    s_add_u32 s59, s58, 101120
    s_mov_b32 m0, s59
    s_add_u32 s58, s58, 0x818000
    v_lshlrev_b32 v243, 4, v1
    s_mov_b64 exec, 0xffffffff
    buffer_load_dwordx4 v243, s[12:15], s58 offen lds
    s_mov_b64 exec, -1
L_skipfirst:
    s_mov_b32 s66, 0
    v_lshrrev_b32 v4, 2, v0
    v_mul_u32_u24 v231, 102400, v4
    v_mov_b32 v220, -1
    v_mov_b32 v221, -1
    s_mov_b32 s38, 372
L_reinit:
    v_mov_b32 v12, 0
    v_mov_b32 v13, 0
    v_mov_b32 v14, 0
    v_mov_b32 v15, 0
    v_lshlrev_b32 v4, 4, v0
    ds_write_b128 v4, v[12:15] offset:27648
    v_cmp_gt_u32 vcc, s38, v0
    v_bfrev_b32 v48, 1
    v_bfrev_b32 v49, 1
    v_bfrev_b32 v50, 1
    v_bfrev_b32 v51, 1
    s_mov_b64 exec, vcc
    ds_write_b128 v4, v[12:15] offset:35840
    s_mov_b64 exec, -1
    v_cmp_gt_u32 vcc, 192, v0
    ds_write_b128 v4, v[48:51] offset:0
    ds_write_b128 v4, v[48:51] offset:8192
    ds_write_b128 v4, v[48:51] offset:16384
    s_mov_b64 exec, vcc
    ds_write_b128 v4, v[48:51] offset:24576
    s_mov_b64 exec, -1
    s_cmp_eq_u32 s34, 0
    s_cbranch_scc0 L_nox2
    s_waitcnt vmcnt(0)
L_nox2:
    s_mov_b32 s38, 336
    v_mov_b32 v11, 4
    s_lshl_b32 s56, s28, 12
    s_add_u32 s56, s56, 0x800000
    s_add_u32 s4, s56, 0x8000
    s_movk_i32 s39, 0xfc
    s_movk_i32 s57, 68
    s_lshl_b32 s5, s28, 1
    s_add_u32 s5, s5, 1
    v_add_u32 v4, s5, v3
    v_mul_u32_u24 v5, 272, v4
    v_lshl_add_u32 v226, v254, 2, v5
    v_add_u32 v4, s5, v253
    v_mul_u32_u24 v4, 272, v4
    v_lshl_add_u32 v4, v254, 2, v4
    v_add_u32 v227, v4, v240
    s_mov_b32 s10, 0x30e400
    s_mov_b32 s18, 0xc35000
    v_lshlrev_b32 v14, 2, v1
    s_cmp_lg_u32 s34, 0
    s_cselect_b64 s[100:101], -1, 0
    s_mov_b64 s[68:69], 0
    s_movk_i32 s3, 80
    s_movk_i32 s67, 96
    s_movk_i32 s7, 112
    s_or_b32 s58, s35, s66
    s_cselect_b64 s[0:1], -1, 0
    s_mov_b32 s58, 0x11111111
    s_mov_b32 s59, 0x11111111
    s_waitcnt lgkmcnt(0)
    s_barrier
    buffer_load_dwordx4 v[80:83], v243, s[12:15], s56 offen offset:0
    buffer_load_dwordx4 v[84:87], v243, s[12:15], s56 offen offset:1024
    buffer_load_dwordx4 v[88:91], v243, s[12:15], s56 offen offset:2048
    buffer_load_dwordx4 v[92:95], v243, s[12:15], s56 offen offset:3072
    s_cmp_lg_u32 s0, 0
    s_cbranch_scc1 L_gen
    s_waitcnt vmcnt(8)
    v_sub_u32_dpp v4, v212, v240 quad_perm:[0,0,0,0] row_mask:0xf bank_mask:0xf
    v_cmp_lt_u32 vcc, 128, v212
    v_cmp_lt_i32 s[40:41], 0, v4
    v_cmp_lt_i32 s[42:43], 16, v4
    v_cmp_lt_i32 s[44:45], 32, v4
    v_cmp_lt_i32 s[46:47], 48, v4
    v_cmp_lt_i32 s[48:49], 64, v4
    v_cmp_lt_i32 s[50:51], s3, v4
    v_cmp_lt_i32 s[52:53], s67, v4
    v_cmp_lt_i32 s[54:55], s7, v4
    s_and_b64 s[68:69], vcc, s[58:59]
    s_andn2_b64 s[40:41], s[40:41], s[58:59]
L_nohdr:
    v_and_b32_sdwa v128, s39, v212 dst_sel:DWORD dst_unused:UNUSED_PAD src0_sel:DWORD src1_sel:BYTE_3
    v_and_b32_sdwa v129, s39, v213 dst_sel:DWORD dst_unused:UNUSED_PAD src0_sel:DWORD src1_sel:BYTE_3
    v_and_b32_sdwa v130, s39, v214 dst_sel:DWORD dst_unused:UNUSED_PAD src0_sel:DWORD src1_sel:BYTE_3
    v_and_b32_sdwa v131, s39, v215 dst_sel:DWORD dst_unused:UNUSED_PAD src0_sel:DWORD src1_sel:BYTE_3
    s_mov_b64 exec, s[40:41]
    ds_add_rtn_u32 v204, v128, v11 offset:40960
    s_mov_b64 exec, s[42:43]
    ds_add_rtn_u32 v205, v129, v11 offset:40960
    s_mov_b64 exec, s[44:45]
    ds_add_rtn_u32 v206, v130, v11 offset:40960
    s_mov_b64 exec, s[46:47]
    ds_add_rtn_u32 v207, v131, v11 offset:40960
    s_waitcnt vmcnt(7)
    s_or_b64 s[58:59], s[48:49], s[0:1]
    s_cbranch_scc0 L_h7
    s_mov_b64 exec, s[48:49]
    v_and_b32_sdwa v132, s39, v216 dst_sel:DWORD dst_unused:UNUSED_PAD src0_sel:DWORD src1_sel:BYTE_3
    ds_add_rtn_u32 v208, v132, v11 offset:40960
    v_lshlrev_b32 v140, 8, v216
    v_bfe_u32 v200, v216, 14, 12
    v_and_b32 v140, 0x3fff00, v140
    v_lshl_add_u32 v200, v200, 5, v231
L_h4:
    s_or_b64 s[58:59], s[50:51], s[0:1]
    s_cbranch_scc0 L_h7
    s_mov_b64 exec, s[50:51]
    v_and_b32_sdwa v133, s39, v217 dst_sel:DWORD dst_unused:UNUSED_PAD src0_sel:DWORD src1_sel:BYTE_3
    ds_add_rtn_u32 v209, v133, v11 offset:40960
    v_lshlrev_b32 v141, 8, v217
    v_bfe_u32 v201, v217, 14, 12
    v_and_b32 v141, 0x3fff00, v141
    v_lshl_add_u32 v201, v201, 5, v231
L_h5:
    s_or_b64 s[58:59], s[52:53], s[0:1]
    s_cbranch_scc0 L_h7
    s_mov_b64 exec, s[52:53]
    v_and_b32_sdwa v134, s39, v218 dst_sel:DWORD dst_unused:UNUSED_PAD src0_sel:DWORD src1_sel:BYTE_3
    ds_add_rtn_u32 v210, v134, v11 offset:40960
    v_lshlrev_b32 v142, 8, v218
    v_bfe_u32 v202, v218, 14, 12
    v_and_b32 v142, 0x3fff00, v142
    v_lshl_add_u32 v202, v202, 5, v231
L_h6:
    s_or_b64 s[58:59], s[54:55], s[0:1]
    s_cbranch_scc0 L_h7
    s_mov_b64 exec, s[54:55]
    v_and_b32_sdwa v135, s39, v219 dst_sel:DWORD dst_unused:UNUSED_PAD src0_sel:DWORD src1_sel:BYTE_3
    ds_add_rtn_u32 v211, v135, v11 offset:40960
    v_lshlrev_b32 v143, 8, v219
    v_bfe_u32 v203, v219, 14, 12
    v_and_b32 v143, 0x3fff00, v143
    v_lshl_add_u32 v203, v203, 5, v231
L_h7:
    s_mov_b64 exec, s[68:69]
    s_cbranch_execz L_noovf
    v_lshrrev_b32 v4, 2, v0
    v_lshrrev_b32 v5, 5, v4
    v_lshlrev_b32 v5, 2, v5
    v_lshlrev_b32 v4, v4, 1
    ds_or_b32 v5, v4 offset:41216
    v_mov_b32 v5, 0
    ds_write_b32 v5, v11 offset:41212
L_noovf:
    s_mov_b64 exec, -1
    v_lshlrev_b32 v136, 8, v212
    v_bfe_u32 v196, v212, 14, 12
    v_and_b32 v136, 0x3fff00, v136
    v_lshl_add_u32 v196, v196, 5, v231
    v_lshlrev_b32 v137, 8, v213
    v_bfe_u32 v197, v213, 14, 12
    v_and_b32 v137, 0x3fff00, v137
    v_lshl_add_u32 v197, v197, 5, v231
    v_lshlrev_b32 v138, 8, v214
    v_bfe_u32 v198, v214, 14, 12
    v_and_b32 v138, 0x3fff00, v138
    v_lshl_add_u32 v198, v198, 5, v231
    v_lshlrev_b32 v139, 8, v215
    v_bfe_u32 v199, v215, 14, 12
    v_and_b32 v139, 0x3fff00, v139
    v_lshl_add_u32 v199, v199, 5, v231
    s_mov_b32 m0, s36
    s_waitcnt lgkmcnt(0)
    v_min_u32 v4, 256, v204
    v_min_u32 v5, 256, v205
    v_min_u32 v6, 256, v206
    v_min_u32 v7, 256, v207
    v_mad_u32_u24 v4, v128, s57, v4
    v_mad_u32_u24 v5, v129, s57, v5
    v_mad_u32_u24 v6, v130, s57, v6
    v_mad_u32_u24 v7, v131, s57, v7
    s_mov_b64 exec, s[40:41]
    ds_write2st64_b32 v4, v136, v196 offset0:0 offset1:54
    s_mov_b64 exec, s[42:43]
    ds_write2st64_b32 v5, v137, v197 offset0:0 offset1:54
    s_mov_b64 exec, s[44:45]
    ds_write2st64_b32 v6, v138, v198 offset0:0 offset1:54
    s_mov_b64 exec, s[46:47]
    ds_write2st64_b32 v7, v139, v199 offset0:0 offset1:54
    s_or_b64 s[58:59], s[48:49], s[0:1]
    s_cbranch_scc0 L_s7
    s_mov_b64 exec, s[48:49]
    v_min_u32 v4, 256, v208
    v_mad_u32_u24 v4, v132, s57, v4
    ds_write2st64_b32 v4, v140, v200 offset0:0 offset1:54
    s_or_b64 s[58:59], s[50:51], s[0:1]
    s_cbranch_scc0 L_s7
    s_mov_b64 exec, s[50:51]
    v_min_u32 v4, 256, v209
    v_mad_u32_u24 v4, v133, s57, v4
    ds_write2st64_b32 v4, v141, v201 offset0:0 offset1:54
    s_or_b64 s[58:59], s[52:53], s[0:1]
    s_cbranch_scc0 L_s7
    s_mov_b64 exec, s[52:53]
    v_min_u32 v4, 256, v210
    v_mad_u32_u24 v4, v134, s57, v4
    ds_write2st64_b32 v4, v142, v202 offset0:0 offset1:54
    s_or_b64 s[58:59], s[54:55], s[0:1]
    s_cbranch_scc0 L_s7
    s_mov_b64 exec, s[54:55]
    v_min_u32 v4, 256, v211
    v_mad_u32_u24 v4, v135, s57, v4
    ds_write2st64_b32 v4, v143, v203 offset0:0 offset1:54
L_s7:
    s_mov_b64 exec, -1
    buffer_load_dwordx4 v[96:99], v243, s[12:15], s4 offen offset:0
    buffer_load_dwordx4 v[100:103], v243, s[12:15], s4 offen offset:1024
    buffer_load_dwordx4 v[104:107], v243, s[12:15], s4 offen offset:2048
    buffer_load_dwordx4 v[108:111], v243, s[12:15], s4 offen offset:3072
    s_waitcnt lgkmcnt(0)
    s_barrier
L_b2done:
    ds_read_b32 v229, v227 offset:13824
    ds_read_b32 v5, v14 offset:40960
    ds_read_b128 v[132:135], v226
    v_and_b32 v4, 15, v1
    v_lshrrev_b32 v6, 4, v1
    v_xor_b32 v6, v6, v4
    v_lshlrev_b32 v6, 4, v6
    v_lshl_add_u32 v244, v4, 8, v6
    v_xor_b32 v245, 64, v244
    v_xor_b32 v246, 128, v244
    v_xor_b32 v247, 192, v244
    s_waitcnt lgkmcnt(2)
    v_add_u32 v229, v229, v239
    buffer_load_dwordx4 v[140:143], v229, s[16:19], 0 offen
    v_and_b32 v4, 7, v1
    v_lshlrev_b32 v236, 4, v4
    v_xor_b32 v156, 64, v236
    s_waitcnt lgkmcnt(0)
    v_readlane_b32 s58, v5, 63
    v_add_u32 v132, v132, v236
    v_add_u32 v133, v133, v156
    v_add_u32 v134, v134, v236
    v_add_u32 v135, v135, v156
    s_cmp_lg_u32 s58, 0
    s_cbranch_scc1 L_ovf1
    v_subrev_u32 v4, 1, v1
    v_cmp_gt_u32 vcc, 16, v4
    v_mul_u32_u24 v8, 784, v1
    v_mul_u32_u24 v12, 272, v1
    v_cndmask_b32 v15, 0, 16, vcc
    v_lshl_add_u32 v12, v15, 2, v12
    s_or_b32 s64, s32, s66
    s_cselect_b32 s67, 0, -1
    s_cselect_b32 s59, -1, 0
    s_cselect_b32 s3, 1, 4
    v_or_b32 v158, 0x80000000, v8
    v_and_b32 v9, s59, v158
    v_lshrrev_b32 v241, 2, v1
    v_cmp_eq_u32 vcc, 12, v240
    v_lshlrev_b32 v4, 9, v241
    v_add_u32 v4, 0x7fffc200, v4
    v_cndmask_b32 v4, 0, v4, vcc
    v_mul_u32_u24 v6, 784, v241
    v_add_u32 v6, 0x80000310, v6
    v_cmp_ne_u32 vcc, 0, v240
    v_bfi_b32 v225, s59, v6, v4
    v_mov_b32 v4, s67
    v_cndmask_b32 v228, 0, v4, vcc
    s_waitcnt vmcnt(9)
    s_barrier
    ds_read_b128 v[16:19], v244 offset:41792
    ds_read_b128 v[20:23], v244 offset:45888
    ds_read_b128 v[24:27], v244 offset:49984
    ds_read_b128 v[28:31], v244 offset:54080
    ds_read_b128 v[32:35], v245 offset:41792
    ds_read_b128 v[36:39], v245 offset:45888
    ds_read_b128 v[40:43], v245 offset:49984
    ds_read_b128 v[44:47], v245 offset:54080
    ds_read_b128 v[48:51], v246 offset:41792
    ds_read_b128 v[52:55], v246 offset:45888
    ds_read_b128 v[56:59], v246 offset:49984
    ds_read_b128 v[60:63], v246 offset:54080
    v_lshrrev_b32 v5, 2, v5
    v_cmp_lt_u32 vcc, 64, v5
    v_min_u32 v5, 64, v5
    v_sub_u32 v5, v5, v15 clamp
    v_add_u32 v5, 3, v5
    v_and_b32 v5, -4, v5
    v_mov_b32 v6, v5
    s_waitcnt lgkmcnt(10)
    s_cmp_lg_u64 vcc, 0
    s_cselect_b32 s33, 1, 0
    v_add_u32_dpp v6, v6, v6 row_shr:1 row_mask:0xf bank_mask:0xf
    s_nop 0
    ds_read_b128 v[64:67], v247 offset:41792
    v_add_u32_dpp v6, v6, v6 row_shr:2 row_mask:0xf bank_mask:0xf
    s_nop 0
    ds_read_b128 v[68:71], v247 offset:45888
    v_add_u32_dpp v6, v6, v6 row_shr:4 row_mask:0xf bank_mask:0xf
    s_nop 0
    ds_read_b128 v[72:75], v247 offset:49984
    v_add_u32_dpp v6, v6, v6 row_shr:8 row_mask:0xf bank_mask:0xf
    s_nop 0
    ds_read_b128 v[76:79], v247 offset:54080
    v_add_u32_dpp v6, v6, v6 row_bcast:15 row_mask:0xa bank_mask:0xf
    s_nop 1
    v_add_u32_dpp v6, v6, v6 row_bcast:31 row_mask:0xc bank_mask:0xf
    v_sub_u32 v7, v6, v5
    s_cmp_lg_u32 s33, 0
    v_readlane_b32 s30, v6, 63
    s_cbranch_scc0 L_nomore
    v_cmp_lt_u32 vcc, 255, v204
    s_and_b64 vcc, vcc, s[40:41]
    s_nop 0
    v_cndmask_b32 v212, -1, v212, vcc
    v_cmp_lt_u32 vcc, 255, v205
    s_and_b64 vcc, vcc, s[42:43]
    s_nop 0
    v_cndmask_b32 v213, -1, v213, vcc
    v_cmp_lt_u32 vcc, 255, v206
    s_and_b64 vcc, vcc, s[44:45]
    s_nop 0
    v_cndmask_b32 v214, -1, v214, vcc
    v_cmp_lt_u32 vcc, 255, v207
    s_and_b64 vcc, vcc, s[46:47]
    s_nop 0
    v_cndmask_b32 v215, -1, v215, vcc
    v_cmp_lt_u32 vcc, 255, v208
    s_and_b64 vcc, vcc, s[48:49]
    s_nop 0
    v_cndmask_b32 v216, -1, v216, vcc
    v_cmp_lt_u32 vcc, 255, v209
    s_and_b64 vcc, vcc, s[50:51]
    s_nop 0
    v_cndmask_b32 v217, -1, v217, vcc
    v_cmp_lt_u32 vcc, 255, v210
    s_and_b64 vcc, vcc, s[52:53]
    s_nop 0
    v_cndmask_b32 v218, -1, v218, vcc
    v_cmp_lt_u32 vcc, 255, v211
    s_and_b64 vcc, vcc, s[54:55]
    s_nop 0
    v_cndmask_b32 v219, -1, v219, vcc
L_nomore:
    s_add_u32 s65, s30, 255
    s_lshr_b32 s65, s65, 8
    s_max_u32 s65, s65, s3
    v_cvt_f32_u32 v6, s65
    s_lshl_b32 s58, s28, 2
    v_rcp_f32 v6, v6
    s_waitcnt vmcnt(5)
    s_waitcnt lgkmcnt(0)
    v_mfma_f32_16x16x32_bf16 v[112:115], v[80:83], v[16:19], 0
    buffer_load_dwordx4 v132, s[8:11], s92 offen offset:0 lds
    v_cmp_lt_u32 s[68:69], s58, v5
    v_mul_f32 v6, 0x47800000, v6
    v_mfma_f32_16x16x32_bf16 v[116:119], v[80:83], v[20:23], 0
    s_add_u32 s59, s58, 4
    v_cvt_u32_f32 v6, v6
    v_add_u32 v4, s58, v7
    v_mfma_f32_16x16x32_bf16 v[120:123], v[80:83], v[24:27], 0
    v_add_u32 v7, 2, v6
    v_cmp_eq_u32 vcc, s59, v5
    s_mov_b32 s39, 0x100000
    v_mfma_f32_16x16x32_bf16 v[124:127], v[80:83], v[28:31], 0
    v_add_u32 v226, 32, v4
    v_cndmask_b32 v6, v9, v158, vcc
    v_mad_u32_u24 v11, v4, v7, s39
    v_mfma_f32_16x16x32_bf16 v[112:115], v[84:87], v[32:35], v[112:115]
    v_mad_u32_u24 v7, v226, v7, s39
    s_add_u32 s59, s58, 36
    v_cmp_eq_u32 vcc, s59, v5
    v_mfma_f32_16x16x32_bf16 v[116:119], v[84:87], v[36:39], v[116:119]
    v_lshrrev_b32 v11, 20, v11
    v_lshrrev_b32 v7, 20, v7
    v_cndmask_b32 v161, v9, v158, vcc
    v_mfma_f32_16x16x32_bf16 v[120:123], v[84:87], v[40:43], v[120:123]
    v_lshl_add_u32 v4, v11, 4, v4
    v_lshl_add_u32 v226, v7, 4, v226
    s_cmp_eq_u32 s58, 0
    s_cselect_b32 s59, 0, s67
    v_mfma_f32_16x16x32_bf16 v[124:127], v[84:87], v[44:47], v[124:127]
    v_lshl_add_u32 v12, s58, 2, v12
    v_mov_b32 v11, s59
    s_add_u32 s58, s58, 32
    v_mfma_f32_16x16x32_bf16 v[112:115], v[88:91], v[48:51], v[112:115]
    v_cmp_lt_u32 vcc, s58, v5
    v_add_u32 v227, 128, v12
    v_mov_b32 v230, s67
    v_mfma_f32_16x16x32_bf16 v[116:119], v[88:91], v[52:55], v[116:119]
    s_lshl_b32 s57, s65, 5
    s_lshl_b32 s7, s65, 4
    s_add_u32 s7, s7, 16
    v_mad_u32_u24 v13, s7, v241, v240
    ds_write2st64_b32 v13, v225, v228 offset0:134 offset1:147
    s_mov_b64 exec, s[68:69]
    ds_write2st64_b32 v4, v12, v8 offset0:108 offset1:121
    ds_write2st64_b32 v4, v6, v11 offset0:134 offset1:147
    s_mov_b64 exec, vcc
    ds_write2st64_b32 v226, v227, v8 offset0:108 offset1:121
    ds_write2st64_b32 v226, v161, v230 offset0:134 offset1:147
    s_mov_b64 exec, -1
    v_mfma_f32_16x16x32_bf16 v[120:123], v[88:91], v[56:59], v[120:123]
    buffer_load_dwordx4 v133, s[8:11], s93 offen offset:1024 lds
    v_lshlrev_b32 v237, 4, v2
    v_add_u32 v237, 57664, v237
    v_mfma_f32_16x16x32_bf16 v[124:127], v[88:91], v[60:63], v[124:127]
    v_and_b32 v5, 16, v1
    v_add_u32 v5, v5, v240
    v_lshlrev_b32 v5, 1, v5
    v_mfma_f32_16x16x32_bf16 v[112:115], v[92:95], v[64:67], v[112:115]
    v_add_u32 v238, 58176, v5
    v_add_u32 v4, s5, v3
    v_mul_u32_u24 v4, 784, v4
    v_mfma_f32_16x16x32_bf16 v[116:119], v[92:95], v[68:71], v[116:119]
    v_add_u32 v224, v4, v238
    v_and_b32 v4, 15, v1
    v_mul_u32_u24 v4, 784, v4
    v_mfma_f32_16x16x32_bf16 v[120:123], v[92:95], v[72:75], v[120:123]
    v_lshrrev_b32 v5, 4, v0
    v_lshl_add_u32 v4, v5, 3, v4
    v_add_u32 v248, 58960, v4
    v_mfma_f32_16x16x32_bf16 v[124:127], v[92:95], v[76:79], v[124:127]
    v_and_b32 v249, 12, v1
    v_mov_b32 v144, 0
    v_mov_b32 v145, 0
    v_mov_b32 v146, 0
    v_mov_b32 v147, 0
    v_lshrrev_b32 v4, 5, v0
    v_mul_u32_u24 v4, 784, v4
    v_add_u32 v4, v4, v237
    v_mul_u32_u24 v5, 320, v3
    v_sub_u32 v5, v4, v5
    v_min_u32 v6, 38416, v8
    s_not_b64 exec, s[0:1]
    ds_write_b128 v4, v[144:147] offset:1568
    ds_write_b128 v4, v[144:147] offset:14112
    ds_write_b128 v4, v[144:147] offset:26656
    s_cmp_eq_u32 s28, 0
    s_cselect_b64 exec, exec, 0
    ds_write_b128 v5, v[144:147] offset:320
    ds_write_b32 v6, v144 offset:58432
    s_mov_b64 exec, -1
    s_mul_i32 s59, s7, s28
    s_lshl_b32 s59, s59, 1
    v_mul_u32_u24 v4, s7, v3
    v_add_u32 v232, s59, v4
    v_add_u32 v233, v232, v249
    v_add_u32 v234, v232, v254
    v_mad_u32_u24 v4, s7, v253, v254
    v_add_u32 v235, s59, v4
    v_add_u32 v14, s7, v232
    buffer_load_dwordx4 v134, s[8:11], s94 offen offset:2048 lds
    s_mov_b32 s58, 0x00010001
    s_and_b32 s58, s58, s100
    s_mov_b32 s59, s58
    v_add_u32 v4, 101120, v243
    s_mov_b64 exec, s[100:101]
    ds_read_b128 v[164:167], v4 offset:0
    ds_read_b128 v[168:171], v4 offset:1024
    ds_read_b128 v[172:175], v4 offset:2048
    ds_read_b128 v[176:179], v4 offset:3072
    v_mul_f32 v112, 0xbfb8aa3b, v112
    v_mul_f32 v113, 0xbfb8aa3b, v113
    v_mul_f32 v114, 0xbfb8aa3b, v114
    v_mul_f32 v115, 0xbfb8aa3b, v115
    v_cvt_pk_bf16_f32 v112, v112, v113
    v_cvt_pk_bf16_f32 v113, v114, v115
    ds_write_b64 v248, v[112:113] offset:0
    v_mul_f32 v116, 0xbfb8aa3b, v116
    v_mul_f32 v117, 0xbfb8aa3b, v117
    v_mul_f32 v118, 0xbfb8aa3b, v118
    v_mul_f32 v119, 0xbfb8aa3b, v119
    v_cvt_pk_bf16_f32 v116, v116, v117
    v_cvt_pk_bf16_f32 v117, v118, v119
    ds_write_b64 v248, v[116:117] offset:12544
    v_mul_f32 v120, 0xbfb8aa3b, v120
    v_mul_f32 v121, 0xbfb8aa3b, v121
    v_mul_f32 v122, 0xbfb8aa3b, v122
    v_mul_f32 v123, 0xbfb8aa3b, v123
    v_cvt_pk_bf16_f32 v120, v120, v121
    v_cvt_pk_bf16_f32 v121, v122, v123
    ds_write_b64 v248, v[120:121] offset:25088
    s_mov_b64 exec, s[58:59]
    v_mul_f32 v124, 0xbfb8aa3b, v124
    v_mul_f32 v125, 0xbfb8aa3b, v125
    v_mul_f32 v126, 0xbfb8aa3b, v126
    v_mul_f32 v127, 0xbfb8aa3b, v127
    v_cvt_pk_bf16_f32 v124, v124, v125
    v_cvt_pk_bf16_f32 v125, v126, v127
    ds_write_b64 v248, v[124:125] offset:37632
    s_mov_b64 exec, -1
    buffer_load_dwordx4 v135, s[8:11], s95 offen offset:3072 lds
    s_waitcnt lgkmcnt(0)
    s_barrier
    ds_read_b32 v6, v235 offset:27664
    ds_read_b32 v7, v234 offset:27664
    ds_read_b32 v227, v235 offset:27680
    ds_read_b32 v226, v234 offset:27680
    ds_read_b32 v12, v14 offset:30972
    ds_read_b32 v13, v14 offset:34300
    v_mov_b32 v5, 0
    ds_write_b32 v232, v5 offset:37648
    ds_read_b128 v[144:147], v5 offset:41216
    ds_read_b64_tr_b16 v[148:149], v224 offset:0
    ds_read_b64_tr_b16 v[150:151], v224 offset:64
    s_mov_b32 m0, s37
    s_nop 0
    buffer_load_dwordx4 v132, s[8:11], s96 offen offset:0 lds
    s_cmp_eq_u32 s34, 0
    s_waitcnt vmcnt(6)
    s_cbranch_scc1 L_noq
    v_mfma_f32_16x16x32_bf16 v[180:183], v[96:99], v[16:19], 0
    v_bfe_u32 v4, v1, 3, 1
    v_mul_u32_u24 v4, 1088, v4
    v_mfma_f32_16x16x32_bf16 v[184:187], v[96:99], v[20:23], 0
    v_lshl_add_u32 v4, v3, 9, v4
    v_add3_u32 v4, v4, v238, s36
    v_mfma_f32_16x16x32_bf16 v[188:191], v[96:99], v[24:27], 0
    v_and_b32 v9, 4, v1
    v_cmp_ne_u32 vcc, 0, v9
    v_mfma_f32_16x16x32_bf16 v[192:195], v[96:99], v[28:31], 0
    v_subrev_u32 v4, 58176, v4
    v_mov_b32 v9, 0x30080
    v_mfma_f32_16x16x32_bf16 v[180:183], v[100:103], v[32:35], v[180:183]
    v_cndmask_b32 v222, v9, v4, vcc
    v_xor_b32 v223, 64, v222
    v_mfma_f32_16x16x32_bf16 v[184:187], v[100:103], v[36:39], v[184:187]
    v_or_b32 v157, 0x80000000, v237
    v_mov_b32 v8, 0x3f80
    v_mfma_f32_16x16x32_bf16 v[188:191], v[100:103], v[40:43], v[188:191]
    v_sub_u32 v4, v253, v3
    v_lshrrev_b32 v9, 3, v2
    v_mfma_f32_16x16x32_bf16 v[192:195], v[100:103], v[44:47], v[192:195]
    v_lshl_add_u32 v4, v4, 2, v9
    v_cmp_gt_u32 vcc, 4, v4
    v_mfma_f32_16x16x32_bf16 v[180:183], v[104:107], v[48:51], v[180:183]
    v_lshlrev_b32 v9, 4, v4
    v_mov_b32 v155, 0
    v_mfma_f32_16x16x32_bf16 v[184:187], v[104:107], v[52:55], v[184:187]
    v_cndmask_b32 v154, 0, v8, vcc
    v_lshlrev_b64 v[154:155], v9, v[154:155]
    v_mfma_f32_16x16x32_bf16 v[188:191], v[104:107], v[56:59], v[188:191]
    v_mfma_f32_16x16x32_bf16 v[192:195], v[104:107], v[60:63], v[192:195]
    v_mfma_f32_16x16x32_bf16 v[180:183], v[108:111], v[64:67], v[180:183]
    v_mfma_f32_16x16x32_bf16 v[184:187], v[108:111], v[68:71], v[184:187]
    v_mfma_f32_16x16x32_bf16 v[188:191], v[108:111], v[72:75], v[188:191]
    v_mfma_f32_16x16x32_bf16 v[192:195], v[108:111], v[76:79], v[192:195]
    s_mov_b32 s34, 0
    s_nop 3
    v_mul_f32 v180, 0xbfb8aa3b, v180
    v_mul_f32 v181, 0xbfb8aa3b, v181
    v_mul_f32 v182, 0xbfb8aa3b, v182
    v_mul_f32 v183, 0xbfb8aa3b, v183
    v_mul_f32 v184, 0xbfb8aa3b, v184
    v_mul_f32 v185, 0xbfb8aa3b, v185
    v_mul_f32 v186, 0xbfb8aa3b, v186
    v_mul_f32 v187, 0xbfb8aa3b, v187
    v_mul_f32 v188, 0xbfb8aa3b, v188
    v_mul_f32 v189, 0xbfb8aa3b, v189
    v_mul_f32 v190, 0xbfb8aa3b, v190
    v_mul_f32 v191, 0xbfb8aa3b, v191
    v_mul_f32 v192, 0xbfb8aa3b, v192
    v_mul_f32 v193, 0xbfb8aa3b, v193
    v_mul_f32 v194, 0xbfb8aa3b, v194
    v_mul_f32 v195, 0xbfb8aa3b, v195
L_noq:
    v_ashrrev_i32 v230, 31, v229
    v_bitop3_b32 v152, v154, v230, v230 bitop3:0x30
    v_bitop3_b32 v153, v155, v230, v230 bitop3:0x30
    buffer_load_dwordx4 v133, s[8:11], s97 offen offset:1024 lds
    buffer_load_dwordx4 v134, s[8:11], s98 offen offset:2048 lds
    s_waitcnt lgkmcnt(0)
    v_add_u32 v6, v6, v240
    ds_read_b32 v228, v6 offset:13824
    ds_read_b128 v[136:139], v7
    v_cmp_eq_u32 vcc, 0, v13
    s_lshl_b32 s58, s28, 10
    s_add_u32 s58, s58, 8704
    v_lshl_add_u32 v4, v3, 9, s58
    s_mov_b64 exec, vcc
    ds_write_b32 v12, v4 offset:58432
    s_mov_b64 exec, -1
    s_mul_i32 s58, s57, s28
    s_sub_i32 s58, s30, s58
    s_max_i32 s58, s58, 0
    s_add_u32 s58, s58, 15
    s_lshr_b32 s58, s58, 4
    s_min_u32 s65, s65, s58
    s_add_u32 s65, s65, 1
    s_mov_b32 s66, 1
    s_mov_b32 s31, 2
    s_cmp_lt_u32 s28, 4
    s_cselect_b32 s58, 48, 16
    v_lshrrev_b32 v15, 4, v0
    v_mul_u32_u24 v6, 784, v15
    s_mul_i32 s59, s58, 784
    v_add_u32 v6, 58448, v6
    v_add_u32 v7, s59, v6
    v_and_b32 v12, 15, v0
    v_lshlrev_b32 v250, 4, v12
    v_add_u32 v4, v250, v6
    v_add_u32 v5, v250, v7
    v_and_b32 v8, 15, v15
    v_xor_b32 v8, v8, v12
    v_lshlrev_b32 v8, 4, v8
    v_lshl_add_u32 v8, v15, 8, v8
    v_add_u32 v8, 97024, v8
    s_lshl_b32 s59, s58, 8
    v_add_u32 v9, s59, v8
    v_lshl_add_u32 v11, v15, 9, v250
    v_lshlrev_b32 v13, 4, v0
    v_lshl_add_u32 v14, v15, 16, v250
    s_lshl_b32 s3, s58, 16
    s_add_u32 s3, s3, s29
    buffer_load_dwordx4 v135, s[8:11], s99 offen offset:3072 lds
    s_cmp_eq_u32 s28, 0
    s_cselect_b32 s6, 0xffff, 0
    s_mov_b32 s7, 0
    s_cmp_lt_u32 s28, 4
    s_cselect_b64 s[6:7], s[6:7], -1
    s_add_u32 s56, s56, 0x10000
    v_lshrrev_b32 v160, 1, v15
    v_xor_b32 v160, v160, v12
    v_lshlrev_b32 v160, 4, v160
    v_lshl_add_u32 v160, v12, 8, v160
    v_and_b32 v255, 1, v15
    v_lshl_add_u32 v160, v255, 3, v160
    v_add_u32 v160, 113408, v160
    v_lshlrev_b32 v255, 3, v15
    v_lshl_add_u32 v255, v12, 1, v255
    v_add_u32 v255, 125696, v255
    v_mov_b32 v15, 0xbfb8aa3b
    s_movk_i32 s39, 0x207
    v_add_u32 v12, 97024, v244
    s_cmp_eq_u32 s35, 0
    s_cbranch_scc0 L_np2
    s_mov_b32 s35, 1
    v_readfirstlane_b32 s60, v144
    v_readfirstlane_b32 s61, v145
    v_readfirstlane_b32 s62, v146
    v_readfirstlane_b32 s63, v147
L_np2:
    s_or_b64 s[58:59], s[60:61], s[62:63]
    s_cselect_b32 s5, 1, s33
    s_lshl_b32 s4, s32, 3
    s_add_u32 s4, s4, s28
    v_mov_b32 v128, 0
    v_mov_b32 v124, 0
    v_mov_b32 v120, 0
    v_mov_b32 v96, 0
    v_mov_b32 v100, 1.0
    v_mov_b32 v129, 0
    v_mov_b32 v125, 0
    v_mov_b32 v121, 0
    v_mov_b32 v97, 0
    v_mov_b32 v101, 1.0
    v_mov_b32 v130, 0
    v_mov_b32 v126, 0
    v_mov_b32 v122, 0
    v_mov_b32 v98, 0
    v_mov_b32 v102, 1.0
    v_mov_b32 v131, 0
    v_mov_b32 v127, 0
    v_mov_b32 v123, 0
    v_mov_b32 v99, 0
    v_mov_b32 v103, 1.0
    s_waitcnt lgkmcnt(0)
    v_add_u32 v229, v228, v239
    v_ashrrev_i32 v230, 31, v229
    s_bitcmp1_b32 s28, 2
    s_cbranch_scc1 L_prime_B
    s_cmp_gt_u32 s65, 1
    s_cselect_b32 s10, s10, 0
    s_cselect_b32 s18, s18, 0
    v_add_u32 v132, v136, v236
    v_add_u32 v133, v137, v156
    v_add_u32 v134, v138, v236
    v_add_u32 v135, v139, v156
    s_mov_b32 m0, s36
    s_waitcnt vmcnt(4)
    ds_read_b64_tr_b16 v[64:65], v222 offset:0
    ds_read_b64_tr_b16 v[66:67], v222 offset:2048
    ds_read_b64_tr_b16 v[68:69], v222 offset:128
    ds_read_b64_tr_b16 v[70:71], v222 offset:2176
    ds_read_b64_tr_b16 v[72:73], v222 offset:256
    ds_read_b64_tr_b16 v[74:75], v222 offset:2304
    ds_read_b64_tr_b16 v[76:77], v222 offset:384
    ds_read_b64_tr_b16 v[78:79], v222 offset:2432
    ds_read_b64_tr_b16 v[80:81], v223 offset:0
    ds_read_b64_tr_b16 v[82:83], v223 offset:2048
    ds_read_b64_tr_b16 v[84:85], v223 offset:128
    ds_read_b64_tr_b16 v[86:87], v223 offset:2176
    ds_read_b64_tr_b16 v[88:89], v223 offset:256
    ds_read_b64_tr_b16 v[90:91], v223 offset:2304
    ds_read_b64_tr_b16 v[92:93], v223 offset:384
    ds_read_b64_tr_b16 v[94:95], v223 offset:2432
    s_waitcnt lgkmcnt(8)
    v_mfma_f32_32x32x8_bf16 v[16:31], v[152:153], v[148:149], v[64:79]
    v_mfma_f32_32x32x16_bf16 v[16:31], v[140:143], v[164:167], v[16:31]
    s_waitcnt lgkmcnt(0)
    s_barrier
    ds_read_b32 v6, v6 offset:768
    ds_read_b32 v7, v7 offset:768
    s_nop 3
    s_waitcnt lgkmcnt(0)
    v_add_u32 v6, v250, v6
    v_add_u32 v7, v250, v7
    s_nop 2
    s_cmp_lg_u32 s64, 0
    s_cbranch_scc1 L_pre_s
    s_setprio 1
    s_waitcnt lgkmcnt(0)
    v_mfma_f32_32x32x8_bf16 v[32:47], v[152:153], v[150:151], v[80:95]
    buffer_load_dwordx4 v132, s[8:11], s92 offen offset:0 lds
    buffer_load_dwordx4 v133, s[8:11], s93 offen offset:1024 lds
    buffer_load_dwordx4 v134, s[8:11], s94 offen offset:2048 lds
    buffer_load_dwordx4 v135, s[8:11], s95 offen offset:3072 lds
    buffer_load_dwordx4 v[144:147], v229, s[16:19], 0 offen
    ds_read_b64_tr_b16 v[148:149], v224 offset:128
    ds_read_b128 v[136:139], v226
    ds_read_b32 v225, v233 offset:30992
    s_waitcnt vmcnt(5)
    ds_read_b64_tr_b16 v[64:65], v222 offset:4096
    ds_read_b64_tr_b16 v[66:67], v222 offset:6144
    ds_read_b64_tr_b16 v[68:69], v222 offset:4224
    ds_read_b64_tr_b16 v[70:71], v222 offset:6272
    ds_read_b64_tr_b16 v[72:73], v222 offset:4352
    ds_read_b64_tr_b16 v[74:75], v222 offset:6400
    ds_read_b64_tr_b16 v[76:77], v222 offset:4480
    ds_read_b64_tr_b16 v[78:79], v222 offset:6528
    ds_read_b64_tr_b16 v[80:81], v223 offset:4096
    ds_read_b64_tr_b16 v[82:83], v223 offset:6144
    ds_read_b64_tr_b16 v[84:85], v223 offset:4224
    ds_read_b64_tr_b16 v[86:87], v223 offset:6272
    ds_read_b64_tr_b16 v[88:89], v223 offset:4352
    ds_read_b64_tr_b16 v[90:91], v223 offset:6400
    ds_read_b64_tr_b16 v[92:93], v223 offset:4480
    ds_read_b64_tr_b16 v[94:95], v223 offset:6528
    v_rcp_f32 v105, v100
    v_mfma_f32_32x32x16_bf16 v[32:47], v[140:143], v[168:171], v[32:47]
    v_rcp_f32 v104, v101
    v_rcp_f32 v107, v102
    v_rcp_f32 v106, v103
    v_exp_f32 v55, v16
    v_exp_f32 v49, v17
    v_exp_f32 v51, v18
    v_exp_f32 v53, v19
    v_exp_f32 v54, v20
    v_exp_f32 v48, v21
    v_exp_f32 v50, v22
    v_exp_f32 v52, v23
    v_exp_f32 v63, v24
    v_exp_f32 v57, v25
    v_exp_f32 v59, v26
    v_exp_f32 v61, v27
    v_exp_f32 v62, v28
    v_exp_f32 v56, v29
    v_exp_f32 v58, v30
    v_exp_f32 v60, v31
    s_branch L_pp0_A
.p2align 6
L_loop_A:
    s_setprio 1
    s_waitcnt lgkmcnt(0)
    v_mfma_f32_32x32x8_bf16 v[32:47], v[152:153], v[150:151], v[80:95]
    ds_read_b64_tr_b16 v[148:149], v224 offset:128
    ds_read_b128 v[136:139], v226
    ds_read_b32 v225, v233 offset:30992
    s_waitcnt vmcnt(5)
    ds_read_b64_tr_b16 v[64:65], v222 offset:4096
    ds_read_b64_tr_b16 v[66:67], v222 offset:6144
    ds_read_b64_tr_b16 v[68:69], v222 offset:4224
    ds_read_b64_tr_b16 v[70:71], v222 offset:6272
    ds_read_b64_tr_b16 v[72:73], v222 offset:4352
    ds_read_b64_tr_b16 v[74:75], v222 offset:6400
    ds_read_b64_tr_b16 v[76:77], v222 offset:4480
    ds_read_b64_tr_b16 v[78:79], v222 offset:6528
    ds_read_b64_tr_b16 v[80:81], v223 offset:4096
    ds_read_b64_tr_b16 v[82:83], v223 offset:6144
    ds_read_b64_tr_b16 v[84:85], v223 offset:4224
    ds_read_b64_tr_b16 v[86:87], v223 offset:6272
    ds_read_b64_tr_b16 v[88:89], v223 offset:4352
    ds_read_b64_tr_b16 v[90:91], v223 offset:6400
    ds_read_b64_tr_b16 v[92:93], v223 offset:4480
    ds_read_b64_tr_b16 v[94:95], v223 offset:6528
    v_rcp_f32 v105, v100
    v_mfma_f32_32x32x16_bf16 v[32:47], v[140:143], v[168:171], v[32:47]
    v_rcp_f32 v104, v101
    v_rcp_f32 v107, v102
    v_rcp_f32 v106, v103
    v_exp_f32 v55, v16
    v_exp_f32 v49, v17
    v_exp_f32 v51, v18
    v_exp_f32 v53, v19
    v_exp_f32 v54, v20
    v_exp_f32 v48, v21
    v_exp_f32 v50, v22
    v_exp_f32 v52, v23
    v_exp_f32 v63, v24
    v_exp_f32 v57, v25
    v_exp_f32 v59, v26
    v_exp_f32 v61, v27
    v_exp_f32 v62, v28
    v_exp_f32 v56, v29
    v_exp_f32 v58, v30
    v_exp_f32 v60, v31
L_pp0_A:
    s_setprio 3
    v_and_b32 v111, v123, v124
    v_add_f32 v100, 1.0, v55
    v_add_f32 v101, 1.0, v54
    v_add_f32 v102, 1.0, v63
    v_fmac_f32 v111, v96, v105
    v_add_f32 v103, 1.0, v62
    v_fma_f32 v17, v17, v100, v16
    v_fma_f32 v21, v21, v101, v20
    v_and_b32 v115, v111, v125
    v_fma_f32 v25, v25, v102, v24
    v_fma_f32 v29, v29, v103, v28
    v_fmac_f32 v17, v16, v49
    v_fmac_f32 v115, v97, v104
    v_fmac_f32 v21, v20, v48
    v_fmac_f32 v25, v24, v57
    v_fmac_f32 v29, v28, v56
    v_and_b32 v119, v115, v126
    v_fmac_f32 v100, v100, v49
    v_fmac_f32 v101, v101, v48
    v_fmac_f32 v102, v102, v57
    v_fmac_f32 v119, v98, v107
    v_fmac_f32 v103, v103, v56
    v_fma_f32 v18, v18, v100, v17
    v_fma_f32 v22, v22, v101, v21
    v_and_b32 v123, v119, v127
    v_fma_f32 v26, v26, v102, v25
    v_fma_f32 v30, v30, v103, v29
    v_fmac_f32 v18, v17, v51
    v_fmac_f32 v123, v99, v106
    v_fmac_f32 v22, v21, v50
    v_fmac_f32 v26, v25, v59
    v_fmac_f32 v30, v29, v58
    v_fmac_f32 v100, v100, v51
    v_fmac_f32 v101, v101, v50
    v_fmac_f32 v102, v102, v59
    v_fmac_f32 v103, v103, v58
    v_fma_f32 v96, v19, v100, v18
    v_fma_f32 v97, v23, v101, v22
    v_fma_f32 v98, v27, v102, v26
    v_fma_f32 v99, v31, v103, v30
    v_fmac_f32 v96, v18, v53
    v_fmac_f32 v97, v22, v52
    v_fmac_f32 v98, v26, v61
    v_fmac_f32 v99, v30, v60
    v_fmac_f32 v100, v100, v53
    v_fmac_f32 v101, v101, v52
    v_fmac_f32 v102, v102, v61
    v_fmac_f32 v103, v103, v60
    v_add_u32 v128, v128, v157
    v_add_u32 v129, v129, v157
    v_add_u32 v130, v130, v157
    v_add_u32 v131, v131, v157
    v_add_u32 v227, v227, v240
    v_bitop3_b32 v220, v220, v104, v105 bitop3:0x80
    v_bitop3_b32 v221, v221, v106, v107 bitop3:0x80
L_tp1_A:
    s_setprio 1
    s_waitcnt lgkmcnt(0)
    s_mov_b32 m0, s37
    ds_read_b128 v[124:127], v232 offset:37632
    ds_read_b64_tr_b16 v[150:151], v224 offset:192
    ds_read_b32 v228, v227 offset:13824
    ds_write_b128 v128, v[108:111]
    ds_write_b128 v129, v[112:115]
    ds_write_b128 v130, v[116:119]
    ds_write_b128 v131, v[120:123]
    buffer_load_dwordx4 v132, s[8:11], s96 offen offset:0 lds
    buffer_load_dwordx4 v133, s[8:11], s97 offen offset:1024 lds
    buffer_load_dwordx4 v134, s[8:11], s98 offen offset:2048 lds
    buffer_load_dwordx4 v135, s[8:11], s99 offen offset:3072 lds
    v_rcp_f32 v105, v100
    v_mfma_f32_32x32x8_bf16 v[16:31], v[152:153], v[148:149], v[64:79]
    v_rcp_f32 v104, v101
    v_rcp_f32 v107, v102
    v_rcp_f32 v106, v103
    v_exp_f32 v55, v32
    v_exp_f32 v49, v33
    v_exp_f32 v51, v34
    v_mfma_f32_32x32x16_bf16 v[16:31], v[140:143], v[172:175], v[16:31]
    v_exp_f32 v53, v35
    v_exp_f32 v54, v36
    v_exp_f32 v48, v37
    v_exp_f32 v50, v38
    v_exp_f32 v52, v39
    v_exp_f32 v63, v40
    v_exp_f32 v57, v41
    v_exp_f32 v59, v42
    v_exp_f32 v61, v43
    v_exp_f32 v62, v44
    v_exp_f32 v56, v45
    v_exp_f32 v58, v46
    v_exp_f32 v60, v47
    s_waitcnt lgkmcnt(6)
    s_setprio 3
    v_and_b32 v108, v120, v124
    v_add_f32 v100, 1.0, v55
    v_add_f32 v101, 1.0, v54
    v_add_f32 v102, 1.0, v63
    v_fmac_f32 v108, v96, v105
    v_add_f32 v103, 1.0, v62
    v_fma_f32 v33, v33, v100, v32
    v_fma_f32 v37, v37, v101, v36
    v_and_b32 v112, v108, v125
    v_fma_f32 v41, v41, v102, v40
    v_fma_f32 v45, v45, v103, v44
    v_fmac_f32 v33, v32, v49
    v_fmac_f32 v112, v97, v104
    v_fmac_f32 v37, v36, v48
    v_fmac_f32 v41, v40, v57
    v_fmac_f32 v45, v44, v56
    v_and_b32 v116, v112, v126
    v_fmac_f32 v100, v100, v49
    v_fmac_f32 v101, v101, v48
    v_fmac_f32 v102, v102, v57
    v_fmac_f32 v116, v98, v107
    v_fmac_f32 v103, v103, v56
    v_fma_f32 v34, v34, v100, v33
    v_fma_f32 v38, v38, v101, v37
    v_and_b32 v120, v116, v127
    v_fma_f32 v42, v42, v102, v41
    v_fma_f32 v46, v46, v103, v45
    v_fmac_f32 v34, v33, v51
    v_fmac_f32 v120, v99, v106
    v_fmac_f32 v38, v37, v50
    v_fmac_f32 v42, v41, v59
    v_fmac_f32 v46, v45, v58
    v_fmac_f32 v100, v100, v51
    v_fmac_f32 v101, v101, v50
    v_fmac_f32 v102, v102, v59
    v_fmac_f32 v103, v103, v58
    v_fma_f32 v96, v35, v100, v34
    v_fma_f32 v97, v39, v101, v38
    v_fma_f32 v98, v43, v102, v42
    v_fma_f32 v99, v47, v103, v46
    v_fmac_f32 v96, v34, v53
    v_fmac_f32 v97, v38, v52
    v_fmac_f32 v98, v42, v61
    v_fmac_f32 v99, v46, v60
    v_fmac_f32 v100, v100, v53
    v_fmac_f32 v101, v101, v52
    v_fmac_f32 v102, v102, v61
    v_fmac_f32 v103, v103, v60
    v_add_u32 v132, v136, v236
    v_add_u32 v133, v137, v156
    v_add_u32 v134, v138, v236
    v_add_u32 v135, v139, v156
    v_add_u32 v224, v225, v238
    v_bitop3_b32 v220, v220, v104, v105 bitop3:0x80
    v_bitop3_b32 v221, v221, v106, v107 bitop3:0x80
    s_setprio 1
    s_waitcnt lgkmcnt(0)
    v_mfma_f32_32x32x8_bf16 v[32:47], v[152:153], v[150:151], v[80:95]
    ds_read_b64_tr_b16 v[148:149], v224 offset:0
    s_cmp_lt_u32 s31, s65
    s_cselect_b32 s10, s10, 0
    s_cselect_b32 s18, s18, 0
    s_add_u32 s31, s31, 1
    s_waitcnt vmcnt(5)
    ds_read_b64_tr_b16 v[64:65], v222 offset:0
    ds_read_b64_tr_b16 v[66:67], v222 offset:2048
    ds_read_b64_tr_b16 v[68:69], v222 offset:128
    ds_read_b64_tr_b16 v[70:71], v222 offset:2176
    ds_read_b64_tr_b16 v[72:73], v222 offset:256
    ds_read_b64_tr_b16 v[74:75], v222 offset:2304
    ds_read_b64_tr_b16 v[76:77], v222 offset:384
    ds_read_b64_tr_b16 v[78:79], v222 offset:2432
    ds_read_b64_tr_b16 v[80:81], v223 offset:0
    ds_read_b64_tr_b16 v[82:83], v223 offset:2048
    ds_read_b64_tr_b16 v[84:85], v223 offset:128
    ds_read_b64_tr_b16 v[86:87], v223 offset:2176
    ds_read_b64_tr_b16 v[88:89], v223 offset:256
    ds_read_b64_tr_b16 v[90:91], v223 offset:2304
    ds_read_b64_tr_b16 v[92:93], v223 offset:384
    ds_read_b64_tr_b16 v[94:95], v223 offset:2432
    v_rcp_f32 v105, v100
    v_mfma_f32_32x32x16_bf16 v[32:47], v[140:143], v[176:179], v[32:47]
    v_rcp_f32 v104, v101
    v_rcp_f32 v107, v102
    v_rcp_f32 v106, v103
    v_exp_f32 v55, v16
    v_exp_f32 v49, v17
    v_exp_f32 v51, v18
    v_exp_f32 v53, v19
    v_exp_f32 v54, v20
    v_exp_f32 v48, v21
    v_exp_f32 v50, v22
    v_exp_f32 v52, v23
    v_exp_f32 v63, v24
    v_exp_f32 v57, v25
    v_exp_f32 v59, v26
    v_exp_f32 v61, v27
    v_exp_f32 v62, v28
    v_exp_f32 v56, v29
    v_exp_f32 v58, v30
    v_exp_f32 v60, v31
    s_setprio 3
    v_and_b32 v109, v121, v124
    v_add_f32 v100, 1.0, v55
    v_add_f32 v101, 1.0, v54
    v_add_f32 v102, 1.0, v63
    v_fmac_f32 v109, v96, v105
    v_add_f32 v103, 1.0, v62
    v_fma_f32 v17, v17, v100, v16
    v_fma_f32 v21, v21, v101, v20
    v_and_b32 v113, v109, v125
    v_fma_f32 v25, v25, v102, v24
    v_fma_f32 v29, v29, v103, v28
    v_fmac_f32 v17, v16, v49
    v_fmac_f32 v113, v97, v104
    v_fmac_f32 v21, v20, v48
    v_fmac_f32 v25, v24, v57
    v_fmac_f32 v29, v28, v56
    v_and_b32 v117, v113, v126
    v_fmac_f32 v100, v100, v49
    v_fmac_f32 v101, v101, v48
    v_fmac_f32 v102, v102, v57
    v_fmac_f32 v117, v98, v107
    v_fmac_f32 v103, v103, v56
    v_fma_f32 v18, v18, v100, v17
    v_fma_f32 v22, v22, v101, v21
    v_and_b32 v121, v117, v127
    v_fma_f32 v26, v26, v102, v25
    v_fma_f32 v30, v30, v103, v29
    v_fmac_f32 v18, v17, v51
    v_fmac_f32 v121, v99, v106
    v_fmac_f32 v22, v21, v50
    v_fmac_f32 v26, v25, v59
    v_fmac_f32 v30, v29, v58
    v_fmac_f32 v100, v100, v51
    v_fmac_f32 v101, v101, v50
    v_fmac_f32 v102, v102, v59
    v_fmac_f32 v103, v103, v58
    v_fma_f32 v96, v19, v100, v18
    v_fma_f32 v97, v23, v101, v22
    v_fma_f32 v98, v27, v102, v26
    v_fma_f32 v99, v31, v103, v30
    v_fmac_f32 v96, v18, v53
    v_fmac_f32 v97, v22, v52
    v_fmac_f32 v98, v26, v61
    v_fmac_f32 v99, v30, v60
    v_fmac_f32 v100, v100, v53
    v_fmac_f32 v101, v101, v52
    v_fmac_f32 v102, v102, v61
    v_fmac_f32 v103, v103, v60
    v_bitop3_b32 v152, v154, v230, v230 bitop3:0x30
    v_bitop3_b32 v153, v155, v230, v230 bitop3:0x30
    v_add_u32 v229, v228, v239
    v_bitop3_b32 v220, v220, v104, v105 bitop3:0x80
    v_bitop3_b32 v221, v221, v106, v107 bitop3:0x80
    s_waitcnt vmcnt(4)
    v_mov_b32 v140, v144
    v_mov_b32 v141, v145
    v_mov_b32 v142, v146
    v_mov_b32 v143, v147
    s_setprio 1
    s_waitcnt lgkmcnt(0)
    s_mov_b32 m0, s36
    ds_read_b64_tr_b16 v[150:151], v224 offset:64
    ds_read_b128 v[128:131], v232 offset:34304
    ds_read_b32 v226, v234 offset:27696
    ds_read_b32 v227, v235 offset:27696
    s_sub_u32 s58, s31, 2
    s_cmp_lt_u32 s58, s65
    buffer_load_dwordx4 v132, s[8:11], s92 offen offset:0 lds
    buffer_load_dwordx4 v133, s[8:11], s93 offen offset:1024 lds
    buffer_load_dwordx4 v134, s[8:11], s94 offen offset:2048 lds
    buffer_load_dwordx4 v135, s[8:11], s95 offen offset:3072 lds
    buffer_load_dwordx4 v[144:147], v229, s[16:19], 0 offen
    v_rcp_f32 v105, v100
    v_mfma_f32_32x32x8_bf16 v[16:31], v[152:153], v[148:149], v[64:79]
    v_rcp_f32 v104, v101
    v_rcp_f32 v107, v102
    v_rcp_f32 v106, v103
    v_exp_f32 v55, v32
    v_exp_f32 v49, v33
    v_exp_f32 v51, v34
    v_mfma_f32_32x32x16_bf16 v[16:31], v[140:143], v[164:167], v[16:31]
    v_exp_f32 v53, v35
    v_exp_f32 v54, v36
    v_exp_f32 v48, v37
    v_exp_f32 v50, v38
    v_exp_f32 v52, v39
    v_exp_f32 v63, v40
    v_exp_f32 v57, v41
    v_exp_f32 v59, v42
    v_exp_f32 v61, v43
    v_exp_f32 v62, v44
    v_exp_f32 v56, v45
    v_exp_f32 v58, v46
    v_exp_f32 v60, v47
    v_ashrrev_i32 v230, 31, v229
    s_setprio 3
    v_and_b32 v110, v122, v124
    v_add_f32 v100, 1.0, v55
    v_add_f32 v101, 1.0, v54
    v_add_f32 v102, 1.0, v63
    v_fmac_f32 v110, v96, v105
    v_add_f32 v103, 1.0, v62
    v_fma_f32 v33, v33, v100, v32
    v_fma_f32 v37, v37, v101, v36
    v_and_b32 v114, v110, v125
    v_fma_f32 v41, v41, v102, v40
    v_fma_f32 v45, v45, v103, v44
    v_fmac_f32 v33, v32, v49
    v_fmac_f32 v114, v97, v104
    v_fmac_f32 v37, v36, v48
    v_fmac_f32 v41, v40, v57
    v_fmac_f32 v45, v44, v56
    v_and_b32 v118, v114, v126
    v_fmac_f32 v100, v100, v49
    v_fmac_f32 v101, v101, v48
    v_fmac_f32 v102, v102, v57
    v_fmac_f32 v118, v98, v107
    v_fmac_f32 v103, v103, v56
    v_fma_f32 v34, v34, v100, v33
    v_fma_f32 v38, v38, v101, v37
    v_and_b32 v122, v118, v127
    v_fma_f32 v42, v42, v102, v41
    v_fma_f32 v46, v46, v103, v45
    v_fmac_f32 v34, v33, v51
    v_fmac_f32 v122, v99, v106
    v_fmac_f32 v38, v37, v50
    v_fmac_f32 v42, v41, v59
    v_fmac_f32 v46, v45, v58
    v_fmac_f32 v100, v100, v51
    v_fmac_f32 v101, v101, v50
    v_fmac_f32 v102, v102, v59
    v_fmac_f32 v103, v103, v58
    v_fma_f32 v96, v35, v100, v34
    v_fma_f32 v97, v39, v101, v38
    v_fma_f32 v98, v43, v102, v42
    v_fma_f32 v99, v47, v103, v46
    v_fmac_f32 v96, v34, v53
    v_fmac_f32 v97, v38, v52
    v_fmac_f32 v98, v42, v61
    v_fmac_f32 v99, v46, v60
    v_fmac_f32 v100, v100, v53
    v_fmac_f32 v101, v101, v52
    v_fmac_f32 v102, v102, v61
    v_fmac_f32 v103, v103, v60
    v_add_u32 v232, 16, v232
    v_add_u32 v233, 16, v233
    v_add_u32 v234, 16, v234
    v_add_u32 v235, 16, v235
    v_bitop3_b32 v220, v220, v104, v105 bitop3:0x80
    v_bitop3_b32 v221, v221, v106, v107 bitop3:0x80
    s_cbranch_scc1 L_loop_A
    buffer_load_dwordx4 v[196:199], v243, s[12:15], s56 offen offset:0
    buffer_load_dwordx4 v[200:203], v243, s[12:15], s56 offen offset:1024
    buffer_load_dwordx4 v[204:207], v243, s[12:15], s56 offen offset:2048
    buffer_load_dwordx4 v[208:211], v243, s[12:15], s56 offen offset:3072
    s_branch L_drain
L_pre_s:
    buffer_load_dwordx4 v132, s[8:11], s92 offen offset:0 lds
    buffer_load_dwordx4 v133, s[8:11], s93 offen offset:1024 lds
    buffer_load_dwordx4 v134, s[8:11], s94 offen offset:2048 lds
    buffer_load_dwordx4 v135, s[8:11], s95 offen offset:3072 lds
    buffer_load_dwordx4 v[144:147], v229, s[16:19], 0 offen
    v_mov_b32 v108, 0
    v_mov_b32 v109, 0
    v_mov_b32 v110, 0
    v_mov_b32 v111, 0
    v_mov_b32 v112, 0
    v_mov_b32 v113, 0
    v_mov_b32 v114, 0
    v_mov_b32 v115, 0
    v_mov_b32 v116, 0
    v_mov_b32 v117, 0
    v_mov_b32 v118, 0
    v_mov_b32 v119, 0
L_loop_s:
    s_setprio 1
    s_waitcnt lgkmcnt(0)
    v_mfma_f32_32x32x8_bf16 v[32:47], v[152:153], v[150:151], v[80:95]
    ds_read_b64_tr_b16 v[148:149], v224 offset:128
    ds_read_b128 v[136:139], v226
    ds_read_b32 v225, v233 offset:30992
    s_waitcnt vmcnt(5)
    ds_read_b64_tr_b16 v[64:65], v222 offset:4096
    ds_read_b64_tr_b16 v[66:67], v222 offset:6144
    ds_read_b64_tr_b16 v[68:69], v222 offset:4224
    ds_read_b64_tr_b16 v[70:71], v222 offset:6272
    ds_read_b64_tr_b16 v[72:73], v222 offset:4352
    ds_read_b64_tr_b16 v[74:75], v222 offset:6400
    ds_read_b64_tr_b16 v[76:77], v222 offset:4480
    ds_read_b64_tr_b16 v[78:79], v222 offset:6528
    ds_read_b64_tr_b16 v[80:81], v223 offset:4096
    ds_read_b64_tr_b16 v[82:83], v223 offset:6144
    ds_read_b64_tr_b16 v[84:85], v223 offset:4224
    ds_read_b64_tr_b16 v[86:87], v223 offset:6272
    ds_read_b64_tr_b16 v[88:89], v223 offset:4352
    ds_read_b64_tr_b16 v[90:91], v223 offset:6400
    ds_read_b64_tr_b16 v[92:93], v223 offset:4480
    ds_read_b64_tr_b16 v[94:95], v223 offset:6528
    v_rcp_f32 v105, v100
    v_mfma_f32_32x32x16_bf16 v[32:47], v[140:143], v[168:171], v[32:47]
    v_rcp_f32 v104, v101
    v_rcp_f32 v107, v102
    v_rcp_f32 v106, v103
    v_exp_f32 v55, v16
    v_exp_f32 v49, v17
    v_exp_f32 v51, v18
    v_exp_f32 v53, v19
    v_exp_f32 v54, v20
    v_exp_f32 v48, v21
    v_exp_f32 v50, v22
    v_exp_f32 v52, v23
    v_exp_f32 v63, v24
    v_exp_f32 v57, v25
    v_exp_f32 v59, v26
    v_exp_f32 v61, v27
    v_exp_f32 v62, v28
    v_exp_f32 v56, v29
    v_exp_f32 v58, v30
    v_exp_f32 v60, v31
L_pp0_s:
    s_setprio 3
    v_and_b32 v111, v123, v124
    v_fmac_f32 v111, v96, v105
    v_and_b32 v115, v111, v125
    v_fmac_f32 v115, v97, v104
    v_and_b32 v119, v115, v126
    v_fmac_f32 v119, v98, v107
    v_and_b32 v123, v119, v127
    v_fmac_f32 v123, v99, v106
    v_add_f32 v48, 1.0, v48
    v_add_f32 v49, 1.0, v49
    v_add_f32 v50, 1.0, v50
    v_add_f32 v51, 1.0, v51
    v_add_f32 v52, 1.0, v52
    v_add_f32 v53, 1.0, v53
    v_add_f32 v54, 1.0, v54
    v_add_f32 v55, 1.0, v55
    v_add_f32 v56, 1.0, v56
    v_add_f32 v57, 1.0, v57
    v_add_f32 v58, 1.0, v58
    v_add_f32 v59, 1.0, v59
    v_add_f32 v60, 1.0, v60
    v_add_f32 v61, 1.0, v61
    v_add_f32 v62, 1.0, v62
    v_add_f32 v63, 1.0, v63
    v_rcp_f32 v48, v48
    v_rcp_f32 v49, v49
    v_rcp_f32 v50, v50
    v_rcp_f32 v51, v51
    v_rcp_f32 v52, v52
    v_rcp_f32 v53, v53
    v_rcp_f32 v54, v54
    v_rcp_f32 v55, v55
    v_rcp_f32 v56, v56
    v_rcp_f32 v57, v57
    v_rcp_f32 v58, v58
    v_rcp_f32 v59, v59
    v_rcp_f32 v60, v60
    v_rcp_f32 v61, v61
    v_rcp_f32 v62, v62
    v_rcp_f32 v63, v63
    v_mul_f32 v96, v16, v55
    v_mul_f32 v97, v20, v54
    v_mul_f32 v98, v24, v63
    v_mul_f32 v99, v28, v62
    v_fmac_f32 v96, v17, v49
    v_fmac_f32 v97, v21, v48
    v_fmac_f32 v98, v25, v57
    v_fmac_f32 v99, v29, v56
    v_fmac_f32 v96, v18, v51
    v_fmac_f32 v97, v22, v50
    v_fmac_f32 v98, v26, v59
    v_fmac_f32 v99, v30, v58
    v_fmac_f32 v96, v19, v53
    v_fmac_f32 v97, v23, v52
    v_fmac_f32 v98, v27, v61
    v_fmac_f32 v99, v31, v60
    v_add_u32 v128, v128, v157
    v_add_u32 v129, v129, v157
    v_add_u32 v130, v130, v157
    v_add_u32 v131, v131, v157
    v_add_u32 v227, v227, v240
L_tp1_s:
    s_setprio 1
    s_waitcnt lgkmcnt(0)
    s_mov_b32 m0, s37
    ds_read_b128 v[124:127], v232 offset:37632
    ds_read_b64_tr_b16 v[150:151], v224 offset:192
    ds_read_b32 v228, v227 offset:13824
    ds_add_f32 v128, v108 offset:0
    ds_add_f32 v128, v109 offset:4
    ds_add_f32 v128, v110 offset:8
    ds_add_f32 v128, v111 offset:12
    s_waitcnt lgkmcnt(0)
    ds_add_f32 v129, v112 offset:0
    ds_add_f32 v129, v113 offset:4
    ds_add_f32 v129, v114 offset:8
    ds_add_f32 v129, v115 offset:12
    s_waitcnt lgkmcnt(0)
    ds_add_f32 v130, v116 offset:0
    ds_add_f32 v130, v117 offset:4
    ds_add_f32 v130, v118 offset:8
    ds_add_f32 v130, v119 offset:12
    s_waitcnt lgkmcnt(0)
    ds_add_f32 v131, v120 offset:0
    ds_add_f32 v131, v121 offset:4
    ds_add_f32 v131, v122 offset:8
    ds_add_f32 v131, v123 offset:12
    s_waitcnt lgkmcnt(0)
    buffer_load_dwordx4 v132, s[8:11], s96 offen offset:0 lds
    buffer_load_dwordx4 v133, s[8:11], s97 offen offset:1024 lds
    buffer_load_dwordx4 v134, s[8:11], s98 offen offset:2048 lds
    buffer_load_dwordx4 v135, s[8:11], s99 offen offset:3072 lds
    v_rcp_f32 v105, v100
    v_mfma_f32_32x32x8_bf16 v[16:31], v[152:153], v[148:149], v[64:79]
    v_rcp_f32 v104, v101
    v_rcp_f32 v107, v102
    v_rcp_f32 v106, v103
    v_exp_f32 v55, v32
    v_exp_f32 v49, v33
    v_exp_f32 v51, v34
    v_mfma_f32_32x32x16_bf16 v[16:31], v[140:143], v[172:175], v[16:31]
    v_exp_f32 v53, v35
    v_exp_f32 v54, v36
    v_exp_f32 v48, v37
    v_exp_f32 v50, v38
    v_exp_f32 v52, v39
    v_exp_f32 v63, v40
    v_exp_f32 v57, v41
    v_exp_f32 v59, v42
    v_exp_f32 v61, v43
    v_exp_f32 v62, v44
    v_exp_f32 v56, v45
    v_exp_f32 v58, v46
    v_exp_f32 v60, v47
    s_waitcnt lgkmcnt(6)
    s_setprio 3
    v_and_b32 v108, v120, v124
    v_fmac_f32 v108, v96, v105
    v_and_b32 v112, v108, v125
    v_fmac_f32 v112, v97, v104
    v_and_b32 v116, v112, v126
    v_fmac_f32 v116, v98, v107
    v_and_b32 v120, v116, v127
    v_fmac_f32 v120, v99, v106
    v_add_f32 v48, 1.0, v48
    v_add_f32 v49, 1.0, v49
    v_add_f32 v50, 1.0, v50
    v_add_f32 v51, 1.0, v51
    v_add_f32 v52, 1.0, v52
    v_add_f32 v53, 1.0, v53
    v_add_f32 v54, 1.0, v54
    v_add_f32 v55, 1.0, v55
    v_add_f32 v56, 1.0, v56
    v_add_f32 v57, 1.0, v57
    v_add_f32 v58, 1.0, v58
    v_add_f32 v59, 1.0, v59
    v_add_f32 v60, 1.0, v60
    v_add_f32 v61, 1.0, v61
    v_add_f32 v62, 1.0, v62
    v_add_f32 v63, 1.0, v63
    v_rcp_f32 v48, v48
    v_rcp_f32 v49, v49
    v_rcp_f32 v50, v50
    v_rcp_f32 v51, v51
    v_rcp_f32 v52, v52
    v_rcp_f32 v53, v53
    v_rcp_f32 v54, v54
    v_rcp_f32 v55, v55
    v_rcp_f32 v56, v56
    v_rcp_f32 v57, v57
    v_rcp_f32 v58, v58
    v_rcp_f32 v59, v59
    v_rcp_f32 v60, v60
    v_rcp_f32 v61, v61
    v_rcp_f32 v62, v62
    v_rcp_f32 v63, v63
    v_mul_f32 v96, v32, v55
    v_mul_f32 v97, v36, v54
    v_mul_f32 v98, v40, v63
    v_mul_f32 v99, v44, v62
    v_fmac_f32 v96, v33, v49
    v_fmac_f32 v97, v37, v48
    v_fmac_f32 v98, v41, v57
    v_fmac_f32 v99, v45, v56
    v_fmac_f32 v96, v34, v51
    v_fmac_f32 v97, v38, v50
    v_fmac_f32 v98, v42, v59
    v_fmac_f32 v99, v46, v58
    v_fmac_f32 v96, v35, v53
    v_fmac_f32 v97, v39, v52
    v_fmac_f32 v98, v43, v61
    v_fmac_f32 v99, v47, v60
    v_add_u32 v132, v136, v236
    v_add_u32 v133, v137, v156
    v_add_u32 v134, v138, v236
    v_add_u32 v135, v139, v156
    v_add_u32 v224, v225, v238
    s_setprio 1
    s_waitcnt lgkmcnt(0)
    v_mfma_f32_32x32x8_bf16 v[32:47], v[152:153], v[150:151], v[80:95]
    ds_read_b64_tr_b16 v[148:149], v224 offset:0
    s_cmp_lt_u32 s31, s65
    s_cselect_b32 s10, s10, 0
    s_cselect_b32 s18, s18, 0
    s_add_u32 s31, s31, 1
    s_waitcnt vmcnt(5)
    ds_read_b64_tr_b16 v[64:65], v222 offset:0
    ds_read_b64_tr_b16 v[66:67], v222 offset:2048
    ds_read_b64_tr_b16 v[68:69], v222 offset:128
    ds_read_b64_tr_b16 v[70:71], v222 offset:2176
    ds_read_b64_tr_b16 v[72:73], v222 offset:256
    ds_read_b64_tr_b16 v[74:75], v222 offset:2304
    ds_read_b64_tr_b16 v[76:77], v222 offset:384
    ds_read_b64_tr_b16 v[78:79], v222 offset:2432
    ds_read_b64_tr_b16 v[80:81], v223 offset:0
    ds_read_b64_tr_b16 v[82:83], v223 offset:2048
    ds_read_b64_tr_b16 v[84:85], v223 offset:128
    ds_read_b64_tr_b16 v[86:87], v223 offset:2176
    ds_read_b64_tr_b16 v[88:89], v223 offset:256
    ds_read_b64_tr_b16 v[90:91], v223 offset:2304
    ds_read_b64_tr_b16 v[92:93], v223 offset:384
    ds_read_b64_tr_b16 v[94:95], v223 offset:2432
    v_rcp_f32 v105, v100
    v_mfma_f32_32x32x16_bf16 v[32:47], v[140:143], v[176:179], v[32:47]
    v_rcp_f32 v104, v101
    v_rcp_f32 v107, v102
    v_rcp_f32 v106, v103
    v_exp_f32 v55, v16
    v_exp_f32 v49, v17
    v_exp_f32 v51, v18
    v_exp_f32 v53, v19
    v_exp_f32 v54, v20
    v_exp_f32 v48, v21
    v_exp_f32 v50, v22
    v_exp_f32 v52, v23
    v_exp_f32 v63, v24
    v_exp_f32 v57, v25
    v_exp_f32 v59, v26
    v_exp_f32 v61, v27
    v_exp_f32 v62, v28
    v_exp_f32 v56, v29
    v_exp_f32 v58, v30
    v_exp_f32 v60, v31
    s_setprio 3
    v_and_b32 v109, v121, v124
    v_fmac_f32 v109, v96, v105
    v_and_b32 v113, v109, v125
    v_fmac_f32 v113, v97, v104
    v_and_b32 v117, v113, v126
    v_fmac_f32 v117, v98, v107
    v_and_b32 v121, v117, v127
    v_fmac_f32 v121, v99, v106
    v_add_f32 v48, 1.0, v48
    v_add_f32 v49, 1.0, v49
    v_add_f32 v50, 1.0, v50
    v_add_f32 v51, 1.0, v51
    v_add_f32 v52, 1.0, v52
    v_add_f32 v53, 1.0, v53
    v_add_f32 v54, 1.0, v54
    v_add_f32 v55, 1.0, v55
    v_add_f32 v56, 1.0, v56
    v_add_f32 v57, 1.0, v57
    v_add_f32 v58, 1.0, v58
    v_add_f32 v59, 1.0, v59
    v_add_f32 v60, 1.0, v60
    v_add_f32 v61, 1.0, v61
    v_add_f32 v62, 1.0, v62
    v_add_f32 v63, 1.0, v63
    v_rcp_f32 v48, v48
    v_rcp_f32 v49, v49
    v_rcp_f32 v50, v50
    v_rcp_f32 v51, v51
    v_rcp_f32 v52, v52
    v_rcp_f32 v53, v53
    v_rcp_f32 v54, v54
    v_rcp_f32 v55, v55
    v_rcp_f32 v56, v56
    v_rcp_f32 v57, v57
    v_rcp_f32 v58, v58
    v_rcp_f32 v59, v59
    v_rcp_f32 v60, v60
    v_rcp_f32 v61, v61
    v_rcp_f32 v62, v62
    v_rcp_f32 v63, v63
    v_mul_f32 v96, v16, v55
    v_mul_f32 v97, v20, v54
    v_mul_f32 v98, v24, v63
    v_mul_f32 v99, v28, v62
    v_fmac_f32 v96, v17, v49
    v_fmac_f32 v97, v21, v48
    v_fmac_f32 v98, v25, v57
    v_fmac_f32 v99, v29, v56
    v_fmac_f32 v96, v18, v51
    v_fmac_f32 v97, v22, v50
    v_fmac_f32 v98, v26, v59
    v_fmac_f32 v99, v30, v58
    v_fmac_f32 v96, v19, v53
    v_fmac_f32 v97, v23, v52
    v_fmac_f32 v98, v27, v61
    v_fmac_f32 v99, v31, v60
    v_bitop3_b32 v152, v154, v230, v230 bitop3:0x30
    v_bitop3_b32 v153, v155, v230, v230 bitop3:0x30
    v_add_u32 v229, v228, v239
    s_waitcnt vmcnt(4)
    v_mov_b32 v140, v144
    v_mov_b32 v141, v145
    v_mov_b32 v142, v146
    v_mov_b32 v143, v147
    s_setprio 1
    s_waitcnt lgkmcnt(0)
    s_mov_b32 m0, s36
    ds_read_b64_tr_b16 v[150:151], v224 offset:64
    ds_read_b128 v[128:131], v232 offset:34304
    ds_read_b32 v226, v234 offset:27696
    ds_read_b32 v227, v235 offset:27696
    s_sub_u32 s58, s31, 2
    s_cmp_lt_u32 s58, s65
    buffer_load_dwordx4 v132, s[8:11], s92 offen offset:0 lds
    buffer_load_dwordx4 v133, s[8:11], s93 offen offset:1024 lds
    buffer_load_dwordx4 v134, s[8:11], s94 offen offset:2048 lds
    buffer_load_dwordx4 v135, s[8:11], s95 offen offset:3072 lds
    buffer_load_dwordx4 v[144:147], v229, s[16:19], 0 offen
    v_rcp_f32 v105, v100
    v_mfma_f32_32x32x8_bf16 v[16:31], v[152:153], v[148:149], v[64:79]
    v_rcp_f32 v104, v101
    v_rcp_f32 v107, v102
    v_rcp_f32 v106, v103
    v_exp_f32 v55, v32
    v_exp_f32 v49, v33
    v_exp_f32 v51, v34
    v_mfma_f32_32x32x16_bf16 v[16:31], v[140:143], v[164:167], v[16:31]
    v_exp_f32 v53, v35
    v_exp_f32 v54, v36
    v_exp_f32 v48, v37
    v_exp_f32 v50, v38
    v_exp_f32 v52, v39
    v_exp_f32 v63, v40
    v_exp_f32 v57, v41
    v_exp_f32 v59, v42
    v_exp_f32 v61, v43
    v_exp_f32 v62, v44
    v_exp_f32 v56, v45
    v_exp_f32 v58, v46
    v_exp_f32 v60, v47
    v_ashrrev_i32 v230, 31, v229
    s_setprio 3
    v_and_b32 v110, v122, v124
    v_fmac_f32 v110, v96, v105
    v_and_b32 v114, v110, v125
    v_fmac_f32 v114, v97, v104
    v_and_b32 v118, v114, v126
    v_fmac_f32 v118, v98, v107
    v_and_b32 v122, v118, v127
    v_fmac_f32 v122, v99, v106
    v_add_f32 v48, 1.0, v48
    v_add_f32 v49, 1.0, v49
    v_add_f32 v50, 1.0, v50
    v_add_f32 v51, 1.0, v51
    v_add_f32 v52, 1.0, v52
    v_add_f32 v53, 1.0, v53
    v_add_f32 v54, 1.0, v54
    v_add_f32 v55, 1.0, v55
    v_add_f32 v56, 1.0, v56
    v_add_f32 v57, 1.0, v57
    v_add_f32 v58, 1.0, v58
    v_add_f32 v59, 1.0, v59
    v_add_f32 v60, 1.0, v60
    v_add_f32 v61, 1.0, v61
    v_add_f32 v62, 1.0, v62
    v_add_f32 v63, 1.0, v63
    v_rcp_f32 v48, v48
    v_rcp_f32 v49, v49
    v_rcp_f32 v50, v50
    v_rcp_f32 v51, v51
    v_rcp_f32 v52, v52
    v_rcp_f32 v53, v53
    v_rcp_f32 v54, v54
    v_rcp_f32 v55, v55
    v_rcp_f32 v56, v56
    v_rcp_f32 v57, v57
    v_rcp_f32 v58, v58
    v_rcp_f32 v59, v59
    v_rcp_f32 v60, v60
    v_rcp_f32 v61, v61
    v_rcp_f32 v62, v62
    v_rcp_f32 v63, v63
    v_mul_f32 v96, v32, v55
    v_mul_f32 v97, v36, v54
    v_mul_f32 v98, v40, v63
    v_mul_f32 v99, v44, v62
    v_fmac_f32 v96, v33, v49
    v_fmac_f32 v97, v37, v48
    v_fmac_f32 v98, v41, v57
    v_fmac_f32 v99, v45, v56
    v_fmac_f32 v96, v34, v51
    v_fmac_f32 v97, v38, v50
    v_fmac_f32 v98, v42, v59
    v_fmac_f32 v99, v46, v58
    v_fmac_f32 v96, v35, v53
    v_fmac_f32 v97, v39, v52
    v_fmac_f32 v98, v43, v61
    v_fmac_f32 v99, v47, v60
    v_add_u32 v232, 16, v232
    v_add_u32 v233, 16, v233
    v_add_u32 v234, 16, v234
    v_add_u32 v235, 16, v235
    s_cbranch_scc1 L_loop_s
    buffer_load_dwordx4 v[196:199], v243, s[12:15], s56 offen offset:0
    buffer_load_dwordx4 v[200:203], v243, s[12:15], s56 offen offset:1024
    buffer_load_dwordx4 v[204:207], v243, s[12:15], s56 offen offset:2048
    buffer_load_dwordx4 v[208:211], v243, s[12:15], s56 offen offset:3072
    v_rcp_f32 v105, v100
    v_rcp_f32 v104, v101
    v_rcp_f32 v107, v102
    v_rcp_f32 v106, v103
    s_waitcnt lgkmcnt(0)
    v_add_u32 v128, v128, v157
    v_add_u32 v129, v129, v157
    v_add_u32 v130, v130, v157
    v_add_u32 v131, v131, v157
    v_and_b32 v111, v123, v124
    v_fmac_f32 v111, v96, v105
    v_and_b32 v115, v111, v125
    v_fmac_f32 v115, v97, v104
    v_and_b32 v119, v115, v126
    v_fmac_f32 v119, v98, v107
    v_and_b32 v123, v119, v127
    v_fmac_f32 v123, v99, v106
    ds_add_f32 v128, v108 offset:0
    ds_add_f32 v128, v109 offset:4
    ds_add_f32 v128, v110 offset:8
    ds_add_f32 v128, v111 offset:12
    s_waitcnt lgkmcnt(0)
    ds_add_f32 v129, v112 offset:0
    ds_add_f32 v129, v113 offset:4
    ds_add_f32 v129, v114 offset:8
    ds_add_f32 v129, v115 offset:12
    s_waitcnt lgkmcnt(0)
    ds_add_f32 v130, v116 offset:0
    ds_add_f32 v130, v117 offset:4
    ds_add_f32 v130, v118 offset:8
    ds_add_f32 v130, v119 offset:12
    s_waitcnt lgkmcnt(0)
    ds_add_f32 v131, v120 offset:0
    ds_add_f32 v131, v121 offset:4
    ds_add_f32 v131, v122 offset:8
    ds_add_f32 v131, v123 offset:12
    s_waitcnt lgkmcnt(0)
    v_bitop3_b32 v220, v220, v104, v105 bitop3:0x80
    v_bitop3_b32 v221, v221, v106, v107 bitop3:0x80
    s_branch L_done
L_prime_B:
    s_cmp_gt_u32 s65, 1
    s_cselect_b32 s10, s10, 0
    s_cselect_b32 s18, s18, 0
    v_add_u32 v132, v136, v236
    v_add_u32 v133, v137, v156
    v_add_u32 v134, v138, v236
    v_add_u32 v135, v139, v156
    s_mov_b32 m0, s36
    s_waitcnt vmcnt(4)
    ds_read_b64_tr_b16 v[64:65], v222 offset:0
    ds_read_b64_tr_b16 v[66:67], v222 offset:2048
    ds_read_b64_tr_b16 v[68:69], v222 offset:128
    ds_read_b64_tr_b16 v[70:71], v222 offset:2176
    ds_read_b64_tr_b16 v[72:73], v222 offset:256
    ds_read_b64_tr_b16 v[74:75], v222 offset:2304
    ds_read_b64_tr_b16 v[76:77], v222 offset:384
    ds_read_b64_tr_b16 v[78:79], v222 offset:2432
    ds_read_b64_tr_b16 v[80:81], v223 offset:0
    ds_read_b64_tr_b16 v[82:83], v223 offset:2048
    ds_read_b64_tr_b16 v[84:85], v223 offset:128
    ds_read_b64_tr_b16 v[86:87], v223 offset:2176
    ds_read_b64_tr_b16 v[88:89], v223 offset:256
    ds_read_b64_tr_b16 v[90:91], v223 offset:2304
    ds_read_b64_tr_b16 v[92:93], v223 offset:384
    ds_read_b64_tr_b16 v[94:95], v223 offset:2432
    s_waitcnt lgkmcnt(8)
    v_mfma_f32_32x32x8_bf16 v[16:31], v[152:153], v[148:149], v[64:79]
    v_mfma_f32_32x32x16_bf16 v[16:31], v[140:143], v[164:167], v[16:31]
    s_waitcnt lgkmcnt(0)
    s_barrier
    ds_read_b32 v6, v6 offset:768
    ds_read_b32 v7, v7 offset:768
    s_nop 3
    s_waitcnt lgkmcnt(0)
    v_add_u32 v6, v250, v6
    v_add_u32 v7, v250, v7
    s_nop 2
    s_cmp_lg_u32 s64, 0
    s_cbranch_scc1 L_pre_s
    s_setprio 2
    s_waitcnt lgkmcnt(0)
    v_rcp_f32 v105, v100
    v_mfma_f32_32x32x8_bf16 v[32:47], v[152:153], v[150:151], v[80:95]
    v_rcp_f32 v104, v101
    v_rcp_f32 v107, v102
    v_rcp_f32 v106, v103
    v_exp_f32 v55, v16
    v_exp_f32 v49, v17
    v_exp_f32 v51, v18
    v_mfma_f32_32x32x16_bf16 v[32:47], v[140:143], v[168:171], v[32:47]
    v_exp_f32 v53, v19
    v_exp_f32 v54, v20
    v_exp_f32 v48, v21
    v_exp_f32 v50, v22
    v_exp_f32 v52, v23
    v_exp_f32 v63, v24
    v_exp_f32 v57, v25
    v_exp_f32 v59, v26
    v_exp_f32 v61, v27
    v_exp_f32 v62, v28
    v_exp_f32 v56, v29
    v_exp_f32 v58, v30
    v_exp_f32 v60, v31
    buffer_load_dwordx4 v132, s[8:11], s92 offen offset:0 lds
    buffer_load_dwordx4 v133, s[8:11], s93 offen offset:1024 lds
    buffer_load_dwordx4 v134, s[8:11], s94 offen offset:2048 lds
    buffer_load_dwordx4 v135, s[8:11], s95 offen offset:3072 lds
    buffer_load_dwordx4 v[144:147], v229, s[16:19], 0 offen
    ds_read_b64_tr_b16 v[148:149], v224 offset:128
    ds_read_b128 v[136:139], v226
    ds_read_b32 v225, v233 offset:30992
    s_waitcnt vmcnt(5)
    ds_read_b64_tr_b16 v[64:65], v222 offset:4096
    ds_read_b64_tr_b16 v[66:67], v222 offset:6144
    ds_read_b64_tr_b16 v[68:69], v222 offset:4224
    ds_read_b64_tr_b16 v[70:71], v222 offset:6272
    ds_read_b64_tr_b16 v[72:73], v222 offset:4352
    ds_read_b64_tr_b16 v[74:75], v222 offset:6400
    ds_read_b64_tr_b16 v[76:77], v222 offset:4480
    ds_read_b64_tr_b16 v[78:79], v222 offset:6528
    ds_read_b64_tr_b16 v[80:81], v223 offset:4096
    ds_read_b64_tr_b16 v[82:83], v223 offset:6144
    ds_read_b64_tr_b16 v[84:85], v223 offset:4224
    ds_read_b64_tr_b16 v[86:87], v223 offset:6272
    ds_read_b64_tr_b16 v[88:89], v223 offset:4352
    ds_read_b64_tr_b16 v[90:91], v223 offset:6400
    ds_read_b64_tr_b16 v[92:93], v223 offset:4480
    ds_read_b64_tr_b16 v[94:95], v223 offset:6528
    s_branch L_pp0_B
.p2align 6
L_loop_B:
    s_setprio 0
    v_and_b32 v110, v122, v124
    v_add_f32 v100, 1.0, v55
    v_add_f32 v101, 1.0, v54
    v_add_f32 v102, 1.0, v63
    v_fmac_f32 v110, v96, v105
    v_add_f32 v103, 1.0, v62
    v_fma_f32 v33, v33, v100, v32
    v_fma_f32 v37, v37, v101, v36
    v_and_b32 v114, v110, v125
    v_fma_f32 v41, v41, v102, v40
    v_fma_f32 v45, v45, v103, v44
    v_fmac_f32 v33, v32, v49
    v_fmac_f32 v114, v97, v104
    v_fmac_f32 v37, v36, v48
    v_fmac_f32 v41, v40, v57
    v_fmac_f32 v45, v44, v56
    v_and_b32 v118, v114, v126
    v_fmac_f32 v100, v100, v49
    v_fmac_f32 v101, v101, v48
    v_fmac_f32 v102, v102, v57
    v_fmac_f32 v118, v98, v107
    v_fmac_f32 v103, v103, v56
    v_fma_f32 v34, v34, v100, v33
    v_fma_f32 v38, v38, v101, v37
    v_and_b32 v122, v118, v127
    v_fma_f32 v42, v42, v102, v41
    v_fma_f32 v46, v46, v103, v45
    v_fmac_f32 v34, v33, v51
    v_fmac_f32 v122, v99, v106
    v_fmac_f32 v38, v37, v50
    v_fmac_f32 v42, v41, v59
    v_fmac_f32 v46, v45, v58
    v_fmac_f32 v100, v100, v51
    v_fmac_f32 v101, v101, v50
    v_fmac_f32 v102, v102, v59
    v_fmac_f32 v103, v103, v58
    v_fma_f32 v96, v35, v100, v34
    v_fma_f32 v97, v39, v101, v38
    v_fma_f32 v98, v43, v102, v42
    v_fma_f32 v99, v47, v103, v46
    v_fmac_f32 v96, v34, v53
    v_fmac_f32 v97, v38, v52
    v_fmac_f32 v98, v42, v61
    v_fmac_f32 v99, v46, v60
    v_fmac_f32 v100, v100, v53
    v_fmac_f32 v101, v101, v52
    v_fmac_f32 v102, v102, v61
    v_fmac_f32 v103, v103, v60
    v_add_u32 v232, 16, v232
    v_add_u32 v233, 16, v233
    v_add_u32 v234, 16, v234
    v_add_u32 v235, 16, v235
    v_bitop3_b32 v220, v220, v104, v105 bitop3:0x80
    v_bitop3_b32 v221, v221, v106, v107 bitop3:0x80
L_mid_B:
    s_setprio 2
    s_waitcnt lgkmcnt(0)
    v_rcp_f32 v105, v100
    v_mfma_f32_32x32x8_bf16 v[32:47], v[152:153], v[150:151], v[80:95]
    v_rcp_f32 v104, v101
    v_rcp_f32 v107, v102
    v_rcp_f32 v106, v103
    v_exp_f32 v55, v16
    v_exp_f32 v49, v17
    v_exp_f32 v51, v18
    v_mfma_f32_32x32x16_bf16 v[32:47], v[140:143], v[168:171], v[32:47]
    v_exp_f32 v53, v19
    v_exp_f32 v54, v20
    v_exp_f32 v48, v21
    v_exp_f32 v50, v22
    v_exp_f32 v52, v23
    v_exp_f32 v63, v24
    v_exp_f32 v57, v25
    v_exp_f32 v59, v26
    v_exp_f32 v61, v27
    v_exp_f32 v62, v28
    v_exp_f32 v56, v29
    v_exp_f32 v58, v30
    v_exp_f32 v60, v31
    ds_read_b64_tr_b16 v[148:149], v224 offset:128
    ds_read_b128 v[136:139], v226
    ds_read_b32 v225, v233 offset:30992
    s_waitcnt vmcnt(5)
    ds_read_b64_tr_b16 v[64:65], v222 offset:4096
    ds_read_b64_tr_b16 v[66:67], v222 offset:6144
    ds_read_b64_tr_b16 v[68:69], v222 offset:4224
    ds_read_b64_tr_b16 v[70:71], v222 offset:6272
    ds_read_b64_tr_b16 v[72:73], v222 offset:4352
    ds_read_b64_tr_b16 v[74:75], v222 offset:6400
    ds_read_b64_tr_b16 v[76:77], v222 offset:4480
    ds_read_b64_tr_b16 v[78:79], v222 offset:6528
    ds_read_b64_tr_b16 v[80:81], v223 offset:4096
    ds_read_b64_tr_b16 v[82:83], v223 offset:6144
    ds_read_b64_tr_b16 v[84:85], v223 offset:4224
    ds_read_b64_tr_b16 v[86:87], v223 offset:6272
    ds_read_b64_tr_b16 v[88:89], v223 offset:4352
    ds_read_b64_tr_b16 v[90:91], v223 offset:6400
    ds_read_b64_tr_b16 v[92:93], v223 offset:4480
    ds_read_b64_tr_b16 v[94:95], v223 offset:6528
L_pp0_B:
    s_setprio 0
    v_and_b32 v111, v123, v124
    v_add_f32 v100, 1.0, v55
    v_add_f32 v101, 1.0, v54
    v_add_f32 v102, 1.0, v63
    v_fmac_f32 v111, v96, v105
    v_add_f32 v103, 1.0, v62
    v_fma_f32 v17, v17, v100, v16
    v_fma_f32 v21, v21, v101, v20
    v_and_b32 v115, v111, v125
    v_fma_f32 v25, v25, v102, v24
    v_fma_f32 v29, v29, v103, v28
    v_fmac_f32 v17, v16, v49
    v_fmac_f32 v115, v97, v104
    v_fmac_f32 v21, v20, v48
    v_fmac_f32 v25, v24, v57
    v_fmac_f32 v29, v28, v56
    v_and_b32 v119, v115, v126
    v_fmac_f32 v100, v100, v49
    v_fmac_f32 v101, v101, v48
    v_fmac_f32 v102, v102, v57
    v_fmac_f32 v119, v98, v107
    v_fmac_f32 v103, v103, v56
    v_fma_f32 v18, v18, v100, v17
    v_fma_f32 v22, v22, v101, v21
    v_and_b32 v123, v119, v127
    v_fma_f32 v26, v26, v102, v25
    v_fma_f32 v30, v30, v103, v29
    v_fmac_f32 v18, v17, v51
    v_fmac_f32 v123, v99, v106
    v_fmac_f32 v22, v21, v50
    v_fmac_f32 v26, v25, v59
    v_fmac_f32 v30, v29, v58
    v_fmac_f32 v100, v100, v51
    v_fmac_f32 v101, v101, v50
    v_fmac_f32 v102, v102, v59
    v_fmac_f32 v103, v103, v58
    v_fma_f32 v96, v19, v100, v18
    v_fma_f32 v97, v23, v101, v22
    v_fma_f32 v98, v27, v102, v26
    v_fma_f32 v99, v31, v103, v30
    v_fmac_f32 v96, v18, v53
    v_fmac_f32 v97, v22, v52
    v_fmac_f32 v98, v26, v61
    v_fmac_f32 v99, v30, v60
    v_fmac_f32 v100, v100, v53
    v_fmac_f32 v101, v101, v52
    v_fmac_f32 v102, v102, v61
    v_fmac_f32 v103, v103, v60
    v_add_u32 v128, v128, v157
    v_add_u32 v129, v129, v157
    v_add_u32 v130, v130, v157
    v_add_u32 v131, v131, v157
    v_add_u32 v227, v227, v240
    v_bitop3_b32 v220, v220, v104, v105 bitop3:0x80
    v_bitop3_b32 v221, v221, v106, v107 bitop3:0x80
L_tp1_B:
    s_setprio 2
    s_waitcnt lgkmcnt(0)
    s_mov_b32 m0, s37
    ds_read_b128 v[124:127], v232 offset:37632
    v_rcp_f32 v105, v100
    v_mfma_f32_32x32x8_bf16 v[16:31], v[152:153], v[148:149], v[64:79]
    v_rcp_f32 v104, v101
    v_rcp_f32 v107, v102
    v_rcp_f32 v106, v103
    v_exp_f32 v55, v32
    v_exp_f32 v49, v33
    v_exp_f32 v51, v34
    v_mfma_f32_32x32x16_bf16 v[16:31], v[140:143], v[172:175], v[16:31]
    v_exp_f32 v53, v35
    v_exp_f32 v54, v36
    v_exp_f32 v48, v37
    v_exp_f32 v50, v38
    v_exp_f32 v52, v39
    v_exp_f32 v63, v40
    v_exp_f32 v57, v41
    v_exp_f32 v59, v42
    v_exp_f32 v61, v43
    v_exp_f32 v62, v44
    v_exp_f32 v56, v45
    v_exp_f32 v58, v46
    v_exp_f32 v60, v47
    ds_read_b64_tr_b16 v[150:151], v224 offset:192
    ds_read_b32 v228, v227 offset:13824
    ds_write_b128 v128, v[108:111]
    ds_write_b128 v129, v[112:115]
    ds_write_b128 v130, v[116:119]
    ds_write_b128 v131, v[120:123]
    buffer_load_dwordx4 v132, s[8:11], s96 offen offset:0 lds
    buffer_load_dwordx4 v133, s[8:11], s97 offen offset:1024 lds
    buffer_load_dwordx4 v134, s[8:11], s98 offen offset:2048 lds
    buffer_load_dwordx4 v135, s[8:11], s99 offen offset:3072 lds
    s_waitcnt lgkmcnt(6)
    s_setprio 0
    v_and_b32 v108, v120, v124
    v_add_f32 v100, 1.0, v55
    v_add_f32 v101, 1.0, v54
    v_add_f32 v102, 1.0, v63
    v_fmac_f32 v108, v96, v105
    v_add_f32 v103, 1.0, v62
    v_fma_f32 v33, v33, v100, v32
    v_fma_f32 v37, v37, v101, v36
    v_and_b32 v112, v108, v125
    v_fma_f32 v41, v41, v102, v40
    v_fma_f32 v45, v45, v103, v44
    v_fmac_f32 v33, v32, v49
    v_fmac_f32 v112, v97, v104
    v_fmac_f32 v37, v36, v48
    v_fmac_f32 v41, v40, v57
    v_fmac_f32 v45, v44, v56
    v_and_b32 v116, v112, v126
    v_fmac_f32 v100, v100, v49
    v_fmac_f32 v101, v101, v48
    v_fmac_f32 v102, v102, v57
    v_fmac_f32 v116, v98, v107
    v_fmac_f32 v103, v103, v56
    v_fma_f32 v34, v34, v100, v33
    v_fma_f32 v38, v38, v101, v37
    v_and_b32 v120, v116, v127
    v_fma_f32 v42, v42, v102, v41
    v_fma_f32 v46, v46, v103, v45
    v_fmac_f32 v34, v33, v51
    v_fmac_f32 v120, v99, v106
    v_fmac_f32 v38, v37, v50
    v_fmac_f32 v42, v41, v59
    v_fmac_f32 v46, v45, v58
    v_fmac_f32 v100, v100, v51
    v_fmac_f32 v101, v101, v50
    v_fmac_f32 v102, v102, v59
    v_fmac_f32 v103, v103, v58
    v_fma_f32 v96, v35, v100, v34
    v_fma_f32 v97, v39, v101, v38
    v_fma_f32 v98, v43, v102, v42
    v_fma_f32 v99, v47, v103, v46
    v_fmac_f32 v96, v34, v53
    v_fmac_f32 v97, v38, v52
    v_fmac_f32 v98, v42, v61
    v_fmac_f32 v99, v46, v60
    v_fmac_f32 v100, v100, v53
    v_fmac_f32 v101, v101, v52
    v_fmac_f32 v102, v102, v61
    v_fmac_f32 v103, v103, v60
    v_add_u32 v132, v136, v236
    v_add_u32 v133, v137, v156
    v_add_u32 v134, v138, v236
    v_add_u32 v135, v139, v156
    v_add_u32 v224, v225, v238
    v_bitop3_b32 v220, v220, v104, v105 bitop3:0x80
    v_bitop3_b32 v221, v221, v106, v107 bitop3:0x80
    s_setprio 2
    s_waitcnt lgkmcnt(0)
    v_rcp_f32 v105, v100
    v_mfma_f32_32x32x8_bf16 v[32:47], v[152:153], v[150:151], v[80:95]
    v_rcp_f32 v104, v101
    v_rcp_f32 v107, v102
    v_rcp_f32 v106, v103
    v_exp_f32 v55, v16
    v_exp_f32 v49, v17
    v_exp_f32 v51, v18
    v_mfma_f32_32x32x16_bf16 v[32:47], v[140:143], v[176:179], v[32:47]
    v_exp_f32 v53, v19
    v_exp_f32 v54, v20
    v_exp_f32 v48, v21
    v_exp_f32 v50, v22
    v_exp_f32 v52, v23
    v_exp_f32 v63, v24
    v_exp_f32 v57, v25
    v_exp_f32 v59, v26
    v_exp_f32 v61, v27
    v_exp_f32 v62, v28
    v_exp_f32 v56, v29
    v_exp_f32 v58, v30
    v_exp_f32 v60, v31
    ds_read_b64_tr_b16 v[148:149], v224 offset:0
    s_cmp_lt_u32 s31, s65
    s_cselect_b32 s10, s10, 0
    s_cselect_b32 s18, s18, 0
    s_add_u32 s31, s31, 1
    s_waitcnt vmcnt(5)
    ds_read_b64_tr_b16 v[64:65], v222 offset:0
    ds_read_b64_tr_b16 v[66:67], v222 offset:2048
    ds_read_b64_tr_b16 v[68:69], v222 offset:128
    ds_read_b64_tr_b16 v[70:71], v222 offset:2176
    ds_read_b64_tr_b16 v[72:73], v222 offset:256
    ds_read_b64_tr_b16 v[74:75], v222 offset:2304
    ds_read_b64_tr_b16 v[76:77], v222 offset:384
    ds_read_b64_tr_b16 v[78:79], v222 offset:2432
    ds_read_b64_tr_b16 v[80:81], v223 offset:0
    ds_read_b64_tr_b16 v[82:83], v223 offset:2048
    ds_read_b64_tr_b16 v[84:85], v223 offset:128
    ds_read_b64_tr_b16 v[86:87], v223 offset:2176
    ds_read_b64_tr_b16 v[88:89], v223 offset:256
    ds_read_b64_tr_b16 v[90:91], v223 offset:2304
    ds_read_b64_tr_b16 v[92:93], v223 offset:384
    ds_read_b64_tr_b16 v[94:95], v223 offset:2432
    s_setprio 0
    v_and_b32 v109, v121, v124
    v_add_f32 v100, 1.0, v55
    v_add_f32 v101, 1.0, v54
    v_add_f32 v102, 1.0, v63
    v_fmac_f32 v109, v96, v105
    v_add_f32 v103, 1.0, v62
    v_fma_f32 v17, v17, v100, v16
    v_fma_f32 v21, v21, v101, v20
    v_and_b32 v113, v109, v125
    v_fma_f32 v25, v25, v102, v24
    v_fma_f32 v29, v29, v103, v28
    v_fmac_f32 v17, v16, v49
    v_fmac_f32 v113, v97, v104
    v_fmac_f32 v21, v20, v48
    v_fmac_f32 v25, v24, v57
    v_fmac_f32 v29, v28, v56
    v_and_b32 v117, v113, v126
    v_fmac_f32 v100, v100, v49
    v_fmac_f32 v101, v101, v48
    v_fmac_f32 v102, v102, v57
    v_fmac_f32 v117, v98, v107
    v_fmac_f32 v103, v103, v56
    v_fma_f32 v18, v18, v100, v17
    v_fma_f32 v22, v22, v101, v21
    v_and_b32 v121, v117, v127
    v_fma_f32 v26, v26, v102, v25
    v_fma_f32 v30, v30, v103, v29
    v_fmac_f32 v18, v17, v51
    v_fmac_f32 v121, v99, v106
    v_fmac_f32 v22, v21, v50
    v_fmac_f32 v26, v25, v59
    v_fmac_f32 v30, v29, v58
    v_fmac_f32 v100, v100, v51
    v_fmac_f32 v101, v101, v50
    v_fmac_f32 v102, v102, v59
    v_fmac_f32 v103, v103, v58
    v_fma_f32 v96, v19, v100, v18
    v_fma_f32 v97, v23, v101, v22
    v_fma_f32 v98, v27, v102, v26
    v_fma_f32 v99, v31, v103, v30
    v_fmac_f32 v96, v18, v53
    v_fmac_f32 v97, v22, v52
    v_fmac_f32 v98, v26, v61
    v_fmac_f32 v99, v30, v60
    v_fmac_f32 v100, v100, v53
    v_fmac_f32 v101, v101, v52
    v_fmac_f32 v102, v102, v61
    v_fmac_f32 v103, v103, v60
    v_bitop3_b32 v152, v154, v230, v230 bitop3:0x30
    v_bitop3_b32 v153, v155, v230, v230 bitop3:0x30
    v_add_u32 v229, v228, v239
    v_bitop3_b32 v220, v220, v104, v105 bitop3:0x80
    v_bitop3_b32 v221, v221, v106, v107 bitop3:0x80
    s_waitcnt vmcnt(4)
    v_mov_b32 v140, v144
    v_mov_b32 v141, v145
    v_mov_b32 v142, v146
    v_mov_b32 v143, v147
    s_setprio 2
    s_waitcnt lgkmcnt(0)
    v_rcp_f32 v105, v100
    v_mfma_f32_32x32x8_bf16 v[16:31], v[152:153], v[148:149], v[64:79]
    v_rcp_f32 v104, v101
    v_rcp_f32 v107, v102
    v_rcp_f32 v106, v103
    v_exp_f32 v55, v32
    v_exp_f32 v49, v33
    v_exp_f32 v51, v34
    v_mfma_f32_32x32x16_bf16 v[16:31], v[140:143], v[164:167], v[16:31]
    v_exp_f32 v53, v35
    v_exp_f32 v54, v36
    v_exp_f32 v48, v37
    v_exp_f32 v50, v38
    v_exp_f32 v52, v39
    v_exp_f32 v63, v40
    v_exp_f32 v57, v41
    v_exp_f32 v59, v42
    v_exp_f32 v61, v43
    v_exp_f32 v62, v44
    v_exp_f32 v56, v45
    v_exp_f32 v58, v46
    v_exp_f32 v60, v47
    v_ashrrev_i32 v230, 31, v229
    s_mov_b32 m0, s36
    ds_read_b64_tr_b16 v[150:151], v224 offset:64
    ds_read_b128 v[128:131], v232 offset:34304
    ds_read_b32 v226, v234 offset:27696
    ds_read_b32 v227, v235 offset:27696
    s_sub_u32 s58, s31, 2
    s_cmp_lt_u32 s58, s65
    buffer_load_dwordx4 v132, s[8:11], s92 offen offset:0 lds
    buffer_load_dwordx4 v133, s[8:11], s93 offen offset:1024 lds
    buffer_load_dwordx4 v134, s[8:11], s94 offen offset:2048 lds
    buffer_load_dwordx4 v135, s[8:11], s95 offen offset:3072 lds
    buffer_load_dwordx4 v[144:147], v229, s[16:19], 0 offen
    s_cbranch_scc1 L_loop_B
    buffer_load_dwordx4 v[196:199], v243, s[12:15], s56 offen offset:0
    buffer_load_dwordx4 v[200:203], v243, s[12:15], s56 offen offset:1024
    buffer_load_dwordx4 v[204:207], v243, s[12:15], s56 offen offset:2048
    buffer_load_dwordx4 v[208:211], v243, s[12:15], s56 offen offset:3072
    s_setprio 0
    v_and_b32 v110, v122, v124
    v_add_f32 v100, 1.0, v55
    v_add_f32 v101, 1.0, v54
    v_add_f32 v102, 1.0, v63
    v_fmac_f32 v110, v96, v105
    v_add_f32 v103, 1.0, v62
    v_fma_f32 v33, v33, v100, v32
    v_fma_f32 v37, v37, v101, v36
    v_and_b32 v114, v110, v125
    v_fma_f32 v41, v41, v102, v40
    v_fma_f32 v45, v45, v103, v44
    v_fmac_f32 v33, v32, v49
    v_fmac_f32 v114, v97, v104
    v_fmac_f32 v37, v36, v48
    v_fmac_f32 v41, v40, v57
    v_fmac_f32 v45, v44, v56
    v_and_b32 v118, v114, v126
    v_fmac_f32 v100, v100, v49
    v_fmac_f32 v101, v101, v48
    v_fmac_f32 v102, v102, v57
    v_fmac_f32 v118, v98, v107
    v_fmac_f32 v103, v103, v56
    v_fma_f32 v34, v34, v100, v33
    v_fma_f32 v38, v38, v101, v37
    v_and_b32 v122, v118, v127
    v_fma_f32 v42, v42, v102, v41
    v_fma_f32 v46, v46, v103, v45
    v_fmac_f32 v34, v33, v51
    v_fmac_f32 v122, v99, v106
    v_fmac_f32 v38, v37, v50
    v_fmac_f32 v42, v41, v59
    v_fmac_f32 v46, v45, v58
    v_fmac_f32 v100, v100, v51
    v_fmac_f32 v101, v101, v50
    v_fmac_f32 v102, v102, v59
    v_fmac_f32 v103, v103, v58
    v_fma_f32 v96, v35, v100, v34
    v_fma_f32 v97, v39, v101, v38
    v_fma_f32 v98, v43, v102, v42
    v_fma_f32 v99, v47, v103, v46
    v_fmac_f32 v96, v34, v53
    v_fmac_f32 v97, v38, v52
    v_fmac_f32 v98, v42, v61
    v_fmac_f32 v99, v46, v60
    v_fmac_f32 v100, v100, v53
    v_fmac_f32 v101, v101, v52
    v_fmac_f32 v102, v102, v61
    v_fmac_f32 v103, v103, v60
    v_add_u32 v232, 16, v232
    v_add_u32 v233, 16, v233
    v_add_u32 v234, 16, v234
    v_add_u32 v235, 16, v235
    v_bitop3_b32 v220, v220, v104, v105 bitop3:0x80
    v_bitop3_b32 v221, v221, v106, v107 bitop3:0x80
L_drain:
    s_setprio 0
    v_rcp_f32 v105, v100
    v_rcp_f32 v104, v101
    v_rcp_f32 v107, v102
    v_rcp_f32 v106, v103
    s_waitcnt lgkmcnt(0)
    v_add_u32 v128, v128, v157
    v_add_u32 v129, v129, v157
    v_add_u32 v130, v130, v157
    v_add_u32 v131, v131, v157
    v_and_b32 v111, v123, v124
    v_fmac_f32 v111, v96, v105
    v_and_b32 v115, v111, v125
    v_fmac_f32 v115, v97, v104
    v_and_b32 v119, v115, v126
    v_fmac_f32 v119, v98, v107
    v_and_b32 v123, v119, v127
    v_fmac_f32 v123, v99, v106
    ds_write_b128 v128, v[108:111]
    ds_write_b128 v129, v[112:115]
    ds_write_b128 v130, v[116:119]
    ds_write_b128 v131, v[120:123]
    v_bitop3_b32 v220, v220, v104, v105 bitop3:0x80
    v_bitop3_b32 v221, v221, v106, v107 bitop3:0x80
    ds_write_b128 v13, v[120:123] offset:49984
L_done:
    s_cmp_lg_u32 s5, 0
    s_waitcnt vmcnt(4) lgkmcnt(0)
    s_barrier
    s_cbranch_scc1 L_again
    ds_read_b128 v[16:19], v4 offset:0
    ds_read_b128 v[20:23], v4 offset:256
    ds_read_b128 v[24:27], v6 offset:41280
    ds_read_b128 v[28:31], v6 offset:41536
    s_cmp_lt_u32 s4, 4
    s_mov_b64 exec, s[6:7]
    ds_read_b128 v[32:35], v5 offset:0
    ds_read_b128 v[36:39], v5 offset:256
    ds_read_b128 v[40:43], v7 offset:41280
    ds_read_b128 v[44:47], v7 offset:41536
    s_mov_b64 exec, -1
    v_and_b32 v250, v220, v221
    v_xor_b32 v4, 64, v12
    v_xor_b32 v5, 128, v12
    v_xor_b32 v6, 192, v12
    v_cmp_gt_u32 vcc, 0x20000000, v250
    s_mov_b32 s58, 0x00010001
    s_mov_b32 s59, 0x00010001
    v_mov_b32 v250, 0
    s_mov_b64 s[68:69], vcc
    s_cbranch_scc0 L_nohead
    ds_read_b128 v[48:51], v11 offset:41792
    ds_read_b128 v[52:55], v11 offset:42048
    s_waitcnt lgkmcnt(0)
    v_add_f32 v16, v16, v48
    v_add_f32 v17, v17, v49
    v_add_f32 v18, v18, v50
    v_add_f32 v19, v19, v51
    v_add_f32 v20, v20, v52
    v_add_f32 v21, v21, v53
    v_add_f32 v22, v22, v54
    v_add_f32 v23, v23, v55
L_nohead:
    s_waitcnt lgkmcnt(4)
    v_add_f32 v16, v16, v24
    v_add_f32 v17, v17, v25
    v_add_f32 v18, v18, v26
    v_add_f32 v19, v19, v27
    v_add_f32 v20, v20, v28
    v_add_f32 v21, v21, v29
    v_add_f32 v22, v22, v30
    v_add_f32 v23, v23, v31
    v_cvt_pk_bf16_f32 v24, v16, v17
    v_cvt_pk_bf16_f32 v25, v18, v19
    v_cvt_pk_bf16_f32 v26, v20, v21
    v_cvt_pk_bf16_f32 v27, v22, v23
    ds_write_b128 v8, v[24:27]
    s_mov_b64 exec, s[6:7]
    s_cbranch_execz L_cv2
    s_waitcnt lgkmcnt(1)
    v_add_f32 v32, v32, v40
    v_add_f32 v33, v33, v41
    v_add_f32 v34, v34, v42
    v_add_f32 v35, v35, v43
    v_add_f32 v36, v36, v44
    v_add_f32 v37, v37, v45
    v_add_f32 v38, v38, v46
    v_add_f32 v39, v39, v47
    v_cvt_pk_bf16_f32 v40, v32, v33
    v_cvt_pk_bf16_f32 v41, v34, v35
    v_cvt_pk_bf16_f32 v42, v36, v37
    v_cvt_pk_bf16_f32 v43, v38, v39
    ds_write_b128 v9, v[40:43]
L_cv2:
    s_mov_b64 exec, -1
    s_waitcnt lgkmcnt(0)
    s_barrier
    ds_read_b128 v[16:19], v12 offset:0
    ds_read_b128 v[20:23], v12 offset:4096
    ds_read_b128 v[32:35], v4 offset:0
    ds_read_b128 v[36:39], v4 offset:4096
    ds_read_b128 v[48:51], v5 offset:0
    ds_read_b128 v[52:55], v5 offset:4096
    ds_read_b128 v[64:67], v6 offset:0
    ds_read_b128 v[68:71], v6 offset:4096
    ds_read_b128 v[24:27], v12 offset:8192
    ds_read_b128 v[40:43], v4 offset:8192
    ds_read_b128 v[56:59], v5 offset:8192
    ds_read_b128 v[72:75], v6 offset:8192
    s_mov_b64 exec, s[58:59]
    ds_read_b128 v[28:31], v12 offset:12288
    ds_read_b128 v[44:47], v4 offset:12288
    ds_read_b128 v[60:63], v5 offset:12288
    s_waitcnt lgkmcnt(13) vmcnt(0)
    ds_read_b128 v[76:79], v6 offset:12288
    s_mov_b64 exec, -1
    s_mov_b32 s58, 0x000f000f
    s_mov_b32 s59, 0x000f000f
    v_mfma_f32_16x16x32_bf16 v[96:99], v[196:199], v[16:19], v[180:183]
    v_mfma_f32_16x16x32_bf16 v[100:103], v[196:199], v[20:23], v[184:187]
    s_waitcnt lgkmcnt(12)
    v_mfma_f32_16x16x32_bf16 v[96:99], v[200:203], v[32:35], v[96:99]
    v_mfma_f32_16x16x32_bf16 v[100:103], v[200:203], v[36:39], v[100:103]
    s_waitcnt lgkmcnt(10)
    v_mfma_f32_16x16x32_bf16 v[96:99], v[204:207], v[48:51], v[96:99]
    v_mfma_f32_16x16x32_bf16 v[100:103], v[204:207], v[52:55], v[100:103]
    s_waitcnt lgkmcnt(8)
    v_mfma_f32_16x16x32_bf16 v[96:99], v[208:211], v[64:67], v[96:99]
    v_mfma_f32_16x16x32_bf16 v[100:103], v[208:211], v[68:71], v[100:103]
    s_waitcnt lgkmcnt(0)
    v_mfma_f32_16x16x32_bf16 v[104:107], v[196:199], v[24:27], v[188:191]
    v_mfma_f32_16x16x32_bf16 v[108:111], v[196:199], v[28:31], v[192:195]
    s_nop 4
    v_exp_f32 v112, v96
    v_mfma_f32_16x16x32_bf16 v[104:107], v[200:203], v[40:43], v[104:107]
    v_exp_f32 v113, v97
    v_mfma_f32_16x16x32_bf16 v[108:111], v[200:203], v[44:47], v[108:111]
    v_exp_f32 v114, v98
    v_mfma_f32_16x16x32_bf16 v[104:107], v[204:207], v[56:59], v[104:107]
    v_exp_f32 v115, v99
    v_mfma_f32_16x16x32_bf16 v[108:111], v[204:207], v[60:63], v[108:111]
    v_exp_f32 v116, v100
    v_mfma_f32_16x16x32_bf16 v[104:107], v[208:211], v[72:75], v[104:107]
    v_exp_f32 v117, v101
    v_mfma_f32_16x16x32_bf16 v[108:111], v[208:211], v[76:79], v[108:111]
    v_exp_f32 v118, v102
    v_exp_f32 v119, v103
    v_fma_f32 v112, v112, v15, v15
    v_fma_f32 v113, v113, v15, v15
    v_fma_f32 v114, v114, v15, v15
    v_fma_f32 v115, v115, v15, v15
    v_fma_f32 v116, v116, v15, v15
    v_fma_f32 v117, v117, v15, v15
    v_fma_f32 v118, v118, v15, v15
    v_fma_f32 v119, v119, v15, v15
    v_rcp_f32 v112, v112
    v_rcp_f32 v113, v113
    v_rcp_f32 v114, v114
    v_rcp_f32 v115, v115
    v_rcp_f32 v116, v116
    v_rcp_f32 v117, v117
    v_rcp_f32 v118, v118
    v_rcp_f32 v119, v119
    v_mul_f32 v112, v96, v112
    v_mul_f32 v113, v97, v113
    v_mul_f32 v114, v98, v114
    v_mul_f32 v115, v99, v115
    v_mul_f32 v116, v100, v116
    v_mul_f32 v117, v101, v117
    v_mul_f32 v118, v102, v118
    v_mul_f32 v119, v103, v119
    v_mov_b32_dpp v108, v109 row_shr:1 row_mask:0xf bank_mask:0xf
    v_cvt_pk_bf16_f32 v112, v112, v113
    v_cvt_pk_bf16_f32 v113, v114, v115
    v_mov_b32_dpp v108, v110 row_shr:2 row_mask:0xf bank_mask:0xf
    ds_write_b64 v160, v[112:113] offset:0
    v_cvt_pk_bf16_f32 v116, v116, v117
    v_mov_b32_dpp v108, v111 row_shr:3 row_mask:0xf bank_mask:0xf
    v_cvt_pk_bf16_f32 v117, v118, v119
    ds_write_b64 v160, v[116:117] offset:4096
    v_add_f32 v96, v96, v100
    v_add_f32 v96, v96, v104
    v_exp_f32 v120, v104
    v_exp_f32 v121, v105
    v_exp_f32 v122, v106
    v_exp_f32 v123, v107
    v_exp_f32 v124, v108
    v_fma_f32 v120, v120, v15, v15
    v_fma_f32 v121, v121, v15, v15
    v_fma_f32 v122, v122, v15, v15
    v_fma_f32 v123, v123, v15, v15
    v_fma_f32 v124, v124, v15, v15
    v_rcp_f32 v120, v120
    v_rcp_f32 v121, v121
    v_rcp_f32 v122, v122
    v_rcp_f32 v123, v123
    v_rcp_f32 v124, v124
    v_mul_f32 v120, v104, v120
    v_mul_f32 v121, v105, v121
    v_mul_f32 v122, v106, v122
    v_mul_f32 v123, v107, v123
    v_mul_f32 v124, v108, v124
    v_cmp_class_f32 vcc, v96, s39
    v_cvt_pk_bf16_f32 v120, v120, v121
    v_cvt_pk_bf16_f32 v121, v122, v123
    ds_write_b64 v160, v[120:121] offset:8192
    s_or_b64 s[68:69], s[68:69], vcc
    s_mov_b64 exec, s[58:59]
    v_cmp_class_f32 vcc, v108, s39
    v_cvt_pk_bf16_f32 v124, v124, v124
    ds_write_b16 v255, v124
    s_or_b64 exec, s[68:69], vcc
    ds_write_b32 v250, v15 offset:41232
    s_mov_b64 exec, -1
    s_waitcnt lgkmcnt(0)
    s_barrier
    ds_read_b128 v[16:19], v8 offset:16384
    s_mov_b64 exec, s[6:7]
    ds_read_b128 v[20:23], v9 offset:16384
    s_mov_b64 exec, -1
    ds_read_b32 v24, v250 offset:41232
    s_waitcnt lgkmcnt(2)
    buffer_store_dwordx4 v[16:19], v14, s[24:27], s29 offen sc1
    s_mov_b64 exec, s[6:7]
    s_cbranch_execz L_st2
    s_waitcnt lgkmcnt(1)
    buffer_store_dwordx4 v[20:23], v14, s[24:27], s3 offen sc1
L_st2:
    s_mov_b64 exec, -1
    s_cmp_lg_u32 s32, 0
    s_cbranch_scc1 L_main_end
    s_waitcnt lgkmcnt(0)
    v_readfirstlane_b32 s58, v24
    s_cmp_eq_u32 s58, 0
    s_cbranch_scc1 L_main_end
    s_mov_b32 s32, 1
    s_waitcnt vmcnt(0)
    s_barrier
    v_mov_b32 v212, 0
    v_and_b32 v9, 3, v0
    v_lshlrev_b32 v5, 5, v0
    v_lshlrev_b32 v9, 4, v9
    v_sub_u32 v5, v5, v9
    s_lshl_b32 s58, s2, 14
    s_add_u32 s58, s58, 0x400000
    v_cmp_gt_u32 vcc, 500, v0
    s_mov_b64 exec, vcc
    s_branch L_cells
L_ovf1:
    s_barrier
    s_cmp_lg_u32 s28, 7
    s_cbranch_scc1 L_ovfe
    v_mov_b32 v4, 0
    ds_read_b128 v[16:19], v4 offset:41216
    ds_write_b32 v4, v4 offset:41212
    v_subrev_u32 v5, 52, v1
    v_lshlrev_b32 v5, 5, v5
    s_waitcnt lgkmcnt(0)
    v_readfirstlane_b32 s60, v16
    v_readfirstlane_b32 s61, v17
    v_readfirstlane_b32 s62, v18
    v_readfirstlane_b32 s63, v19
    s_ff1_i32_b64 s58, s[60:61]
    s_ff1_i32_b64 s59, s[62:63]
    s_add_u32 s59, s59, 64
    s_cmp_eq_i32 s58, -1
    s_cselect_b32 s3, s59, s58
    s_mov_b32 s68, 0
    s_mov_b32 s69, 0xfff00000
    s_mov_b64 exec, s[68:69]
    s_lshl_b32 s58, s3, 2
    s_add_u32 s58, s58, 0x900000
    buffer_load_dword v6, v4, s[12:15], s58 offen
    s_mul_i32 s59, s3, 12800
    s_add_u32 s58, s59, 0x910000
    buffer_load_dwordx4 v[212:215], v5, s[12:15], s58 offen
    buffer_load_dwordx4 v[216:219], v5, s[12:15], s58 offen offset:16
    s_add_u32 s58, s59, 0xb00000
    buffer_load_dwordx4 v[16:19], v5, s[12:15], s58 offen
    buffer_load_dwordx4 v[20:23], v5, s[12:15], s58 offen offset:16
    s_mul_i32 s59, s3, 102400
    v_mov_b32 v231, s59
    s_mul_i32 s7, s2, 132
    s_waitcnt vmcnt(0)
    v_cmp_lt_u32 vcc, 384, v6
    s_cbranch_vccnz L_ovfe
    s_mov_b64 exec, s[68:69]
    v_add_u32 v7, 0, v5
    v_cmp_lt_u32 vcc, v7, v6
    v_cmp_eq_u32 s[58:59], s7, v16
    s_and_b64 vcc, vcc, s[58:59]
    s_or_b64 s[40:41], s[40:41], vcc
    v_and_b32_sdwa v128, s39, v212 dst_sel:DWORD dst_unused:UNUSED_PAD src0_sel:DWORD src1_sel:BYTE_3
    v_lshlrev_b32 v136, 8, v212
    v_bfe_u32 v196, v212, 14, 12
    v_and_b32 v136, 0x3fff00, v136
    v_lshl_add_u32 v196, v196, 5, v231
    s_mov_b64 exec, vcc
    ds_add_rtn_u32 v204, v128, v11 offset:40960
    s_waitcnt lgkmcnt(0)
    v_min_u32 v7, 256, v204
    v_mad_u32_u24 v7, v128, s57, v7
    ds_write2st64_b32 v7, v136, v196 offset0:0 offset1:54
    s_mov_b64 exec, s[68:69]
    v_add_u32 v7, 4, v5
    v_cmp_lt_u32 vcc, v7, v6
    v_cmp_eq_u32 s[58:59], s7, v17
    s_and_b64 vcc, vcc, s[58:59]
    s_or_b64 s[42:43], s[42:43], vcc
    v_and_b32_sdwa v129, s39, v213 dst_sel:DWORD dst_unused:UNUSED_PAD src0_sel:DWORD src1_sel:BYTE_3
    v_lshlrev_b32 v137, 8, v213
    v_bfe_u32 v197, v213, 14, 12
    v_and_b32 v137, 0x3fff00, v137
    v_lshl_add_u32 v197, v197, 5, v231
    s_mov_b64 exec, vcc
    ds_add_rtn_u32 v205, v129, v11 offset:40960
    s_waitcnt lgkmcnt(0)
    v_min_u32 v7, 256, v205
    v_mad_u32_u24 v7, v129, s57, v7
    ds_write2st64_b32 v7, v137, v197 offset0:0 offset1:54
    s_mov_b64 exec, s[68:69]
    v_add_u32 v7, 8, v5
    v_cmp_lt_u32 vcc, v7, v6
    v_cmp_eq_u32 s[58:59], s7, v18
    s_and_b64 vcc, vcc, s[58:59]
    s_or_b64 s[44:45], s[44:45], vcc
    v_and_b32_sdwa v130, s39, v214 dst_sel:DWORD dst_unused:UNUSED_PAD src0_sel:DWORD src1_sel:BYTE_3
    v_lshlrev_b32 v138, 8, v214
    v_bfe_u32 v198, v214, 14, 12
    v_and_b32 v138, 0x3fff00, v138
    v_lshl_add_u32 v198, v198, 5, v231
    s_mov_b64 exec, vcc
    ds_add_rtn_u32 v206, v130, v11 offset:40960
    s_waitcnt lgkmcnt(0)
    v_min_u32 v7, 256, v206
    v_mad_u32_u24 v7, v130, s57, v7
    ds_write2st64_b32 v7, v138, v198 offset0:0 offset1:54
    s_mov_b64 exec, s[68:69]
    v_add_u32 v7, 12, v5
    v_cmp_lt_u32 vcc, v7, v6
    v_cmp_eq_u32 s[58:59], s7, v19
    s_and_b64 vcc, vcc, s[58:59]
    s_or_b64 s[46:47], s[46:47], vcc
    v_and_b32_sdwa v131, s39, v215 dst_sel:DWORD dst_unused:UNUSED_PAD src0_sel:DWORD src1_sel:BYTE_3
    v_lshlrev_b32 v139, 8, v215
    v_bfe_u32 v199, v215, 14, 12
    v_and_b32 v139, 0x3fff00, v139
    v_lshl_add_u32 v199, v199, 5, v231
    s_mov_b64 exec, vcc
    ds_add_rtn_u32 v207, v131, v11 offset:40960
    s_waitcnt lgkmcnt(0)
    v_min_u32 v7, 256, v207
    v_mad_u32_u24 v7, v131, s57, v7
    ds_write2st64_b32 v7, v139, v199 offset0:0 offset1:54
    s_mov_b64 exec, s[68:69]
    v_add_u32 v7, 16, v5
    v_cmp_lt_u32 vcc, v7, v6
    v_cmp_eq_u32 s[58:59], s7, v20
    s_and_b64 vcc, vcc, s[58:59]
    s_or_b64 s[48:49], s[48:49], vcc
    v_and_b32_sdwa v132, s39, v216 dst_sel:DWORD dst_unused:UNUSED_PAD src0_sel:DWORD src1_sel:BYTE_3
    v_lshlrev_b32 v140, 8, v216
    v_bfe_u32 v200, v216, 14, 12
    v_and_b32 v140, 0x3fff00, v140
    v_lshl_add_u32 v200, v200, 5, v231
    s_mov_b64 exec, vcc
    ds_add_rtn_u32 v208, v132, v11 offset:40960
    s_waitcnt lgkmcnt(0)
    v_min_u32 v7, 256, v208
    v_mad_u32_u24 v7, v132, s57, v7
    ds_write2st64_b32 v7, v140, v200 offset0:0 offset1:54
    s_mov_b64 exec, s[68:69]
    v_add_u32 v7, 20, v5
    v_cmp_lt_u32 vcc, v7, v6
    v_cmp_eq_u32 s[58:59], s7, v21
    s_and_b64 vcc, vcc, s[58:59]
    s_or_b64 s[50:51], s[50:51], vcc
    v_and_b32_sdwa v133, s39, v217 dst_sel:DWORD dst_unused:UNUSED_PAD src0_sel:DWORD src1_sel:BYTE_3
    v_lshlrev_b32 v141, 8, v217
    v_bfe_u32 v201, v217, 14, 12
    v_and_b32 v141, 0x3fff00, v141
    v_lshl_add_u32 v201, v201, 5, v231
    s_mov_b64 exec, vcc
    ds_add_rtn_u32 v209, v133, v11 offset:40960
    s_waitcnt lgkmcnt(0)
    v_min_u32 v7, 256, v209
    v_mad_u32_u24 v7, v133, s57, v7
    ds_write2st64_b32 v7, v141, v201 offset0:0 offset1:54
    s_mov_b64 exec, s[68:69]
    v_add_u32 v7, 24, v5
    v_cmp_lt_u32 vcc, v7, v6
    v_cmp_eq_u32 s[58:59], s7, v22
    s_and_b64 vcc, vcc, s[58:59]
    s_or_b64 s[52:53], s[52:53], vcc
    v_and_b32_sdwa v134, s39, v218 dst_sel:DWORD dst_unused:UNUSED_PAD src0_sel:DWORD src1_sel:BYTE_3
    v_lshlrev_b32 v142, 8, v218
    v_bfe_u32 v202, v218, 14, 12
    v_and_b32 v142, 0x3fff00, v142
    v_lshl_add_u32 v202, v202, 5, v231
    s_mov_b64 exec, vcc
    ds_add_rtn_u32 v210, v134, v11 offset:40960
    s_waitcnt lgkmcnt(0)
    v_min_u32 v7, 256, v210
    v_mad_u32_u24 v7, v134, s57, v7
    ds_write2st64_b32 v7, v142, v202 offset0:0 offset1:54
    s_mov_b64 exec, s[68:69]
    v_add_u32 v7, 28, v5
    v_cmp_lt_u32 vcc, v7, v6
    v_cmp_eq_u32 s[58:59], s7, v23
    s_and_b64 vcc, vcc, s[58:59]
    s_or_b64 s[54:55], s[54:55], vcc
    v_and_b32_sdwa v135, s39, v219 dst_sel:DWORD dst_unused:UNUSED_PAD src0_sel:DWORD src1_sel:BYTE_3
    v_lshlrev_b32 v143, 8, v219
    v_bfe_u32 v203, v219, 14, 12
    v_and_b32 v143, 0x3fff00, v143
    v_lshl_add_u32 v203, v203, 5, v231
    s_mov_b64 exec, vcc
    ds_add_rtn_u32 v211, v135, v11 offset:40960
    s_waitcnt lgkmcnt(0)
    v_min_u32 v7, 256, v211
    v_mad_u32_u24 v7, v135, s57, v7
    ds_write2st64_b32 v7, v143, v203 offset0:0 offset1:54
    s_mov_b64 exec, 1
    s_lshr_b32 s58, s3, 5
    s_lshl_b32 s58, s58, 2
    s_lshl_b32 s59, 1, s3
    v_mov_b32 v5, s58
    v_mov_b32 v6, s59
    ds_xor_b32 v5, v6 offset:41216
L_ovfe:
    s_mov_b64 exec, -1
    s_waitcnt vmcnt(0) lgkmcnt(0)
    s_barrier
    s_branch L_b2done
L_gen:
    v_cmp_ne_u32 s[40:41], -1, v212
    v_cmp_ne_u32 s[42:43], -1, v213
    v_cmp_ne_u32 s[44:45], -1, v214
    v_cmp_ne_u32 s[46:47], -1, v215
    v_cmp_ne_u32 s[48:49], -1, v216
    v_cmp_ne_u32 s[50:51], -1, v217
    v_cmp_ne_u32 s[52:53], -1, v218
    v_cmp_ne_u32 s[54:55], -1, v219
    s_branch L_nohdr
L_again:
    s_cmp_lg_u32 s33, 0
    s_cbranch_scc1 L_reinit
    s_ff1_i32_b64 s58, s[60:61]
    s_cmp_eq_i32 s58, -1
    s_cbranch_scc1 L_pophi
    s_bitset0_b64 s[60:61], s58
    s_branch L_popped
L_pophi:
    s_ff1_i32_b64 s58, s[62:63]
    s_bitset0_b64 s[62:63], s58
    s_add_u32 s58, s58, 64
L_popped:
    s_mul_i32 s59, s58, 102400
    v_mov_b32 v231, s59
    s_mul_i32 s59, s58, 12800
    s_lshl_b32 s58, s58, 2
    s_add_u32 s58, s58, 0x900000
    v_mov_b32 v4, 0
    v_lshlrev_b32 v5, 5, v0
    buffer_load_dword v6, v4, s[12:15], s58 offen
    s_add_u32 s58, s59, 0x910000
    buffer_load_dwordx4 v[212:215], v5, s[12:15], s58 offen
    buffer_load_dwordx4 v[216:219], v5, s[12:15], s58 offen offset:16
    s_add_u32 s58, s59, 0xb00000
    buffer_load_dwordx4 v[48:51], v5, s[12:15], s58 offen
    buffer_load_dwordx4 v[52:55], v5, s[12:15], s58 offen offset:16
    s_mul_i32 s57, s2, 132
    s_waitcnt vmcnt(0)
    v_add_u32 v8, 0, v5
    v_cmp_lt_u32 vcc, v8, v6
    v_cmp_eq_u32 s[58:59], s57, v48
    s_and_b64 vcc, vcc, s[58:59]
    s_nop 0
    v_cndmask_b32 v212, -1, v212, vcc
    v_add_u32 v8, 4, v5
    v_cmp_lt_u32 vcc, v8, v6
    v_cmp_eq_u32 s[58:59], s57, v49
    s_and_b64 vcc, vcc, s[58:59]
    s_nop 0
    v_cndmask_b32 v213, -1, v213, vcc
    v_add_u32 v8, 8, v5
    v_cmp_lt_u32 vcc, v8, v6
    v_cmp_eq_u32 s[58:59], s57, v50
    s_and_b64 vcc, vcc, s[58:59]
    s_nop 0
    v_cndmask_b32 v214, -1, v214, vcc
    v_add_u32 v8, 12, v5
    v_cmp_lt_u32 vcc, v8, v6
    v_cmp_eq_u32 s[58:59], s57, v51
    s_and_b64 vcc, vcc, s[58:59]
    s_nop 0
    v_cndmask_b32 v215, -1, v215, vcc
    v_add_u32 v8, 16, v5
    v_cmp_lt_u32 vcc, v8, v6
    v_cmp_eq_u32 s[58:59], s57, v52
    s_and_b64 vcc, vcc, s[58:59]
    s_nop 0
    v_cndmask_b32 v216, -1, v216, vcc
    v_add_u32 v8, 20, v5
    v_cmp_lt_u32 vcc, v8, v6
    v_cmp_eq_u32 s[58:59], s57, v53
    s_and_b64 vcc, vcc, s[58:59]
    s_nop 0
    v_cndmask_b32 v217, -1, v217, vcc
    v_add_u32 v8, 24, v5
    v_cmp_lt_u32 vcc, v8, v6
    v_cmp_eq_u32 s[58:59], s57, v54
    s_and_b64 vcc, vcc, s[58:59]
    s_nop 0
    v_cndmask_b32 v218, -1, v218, vcc
    v_add_u32 v8, 28, v5
    v_cmp_lt_u32 vcc, v8, v6
    v_cmp_eq_u32 s[58:59], s57, v55
    s_and_b64 vcc, vcc, s[58:59]
    s_nop 0
    v_cndmask_b32 v219, -1, v219, vcc
    s_branch L_reinit
L_main_end:
    s_endpgm
.section .rodata,"a"
.p2align 6
.amdhsa_kernel pre_kernel
  .amdhsa_next_free_vgpr 160
  .amdhsa_next_free_sgpr 102
  .amdhsa_accum_offset 160
  .amdhsa_group_segment_fixed_size 0
  .amdhsa_kernarg_size 72
  .amdhsa_user_sgpr_count 2
  .amdhsa_user_sgpr_kernarg_segment_ptr 1
  .amdhsa_system_sgpr_workgroup_id_x 1
  .amdhsa_float_denorm_mode_32 3
.end_amdhsa_kernel
.p2align 6
.amdhsa_kernel main_kernel
  .amdhsa_next_free_vgpr 256
  .amdhsa_next_free_sgpr 102
  .amdhsa_accum_offset 256
  .amdhsa_group_segment_fixed_size 0
  .amdhsa_kernarg_size 72
  .amdhsa_user_sgpr_count 2
  .amdhsa_user_sgpr_kernarg_segment_ptr 1
  .amdhsa_system_sgpr_workgroup_id_x 1
  .amdhsa_float_denorm_mode_32 3
.end_amdhsa_kernel
```
